```python
import torch

def _softmax(x, axis=-1):
    return torch.softmax(x, dim=axis)
def _gelu(x):
    return torch.nn.functional.gelu(x, approximate="tanh")
def _silu(x):
    return torch.nn.functional.silu(x)
def _sigmoid(x):
    return torch.sigmoid(x)
def _layernorm(x, axis=-1, eps=1e-5):
    m = x.mean(dim=axis, keepdim=True)
    v = x.var(dim=axis, keepdim=True, unbiased=False)
    return (x - m) / torch.sqrt(v + eps)
def _scatter_add(tgt, idx, src, axis=0):
    return tgt.clone().index_add_(axis, idx, src)
def _segment_sum(src, seg, n):
    out = torch.zeros((n,) + src.shape[1:], dtype=src.dtype)
    return out.index_add_(0, seg, src)
def _pad(x, pw):
    flat = tuple(v for pair in reversed(pw) for v in pair)
    return torch.nn.functional.pad(x, flat)

kernel_name = 'concat_heads__compressed_kv_cla__mha_block_cached__decode'

def setup_inputs():

    _w = (lambda a: (lambda t: t.to(torch.bfloat16) if t.is_floating_point() else t)(torch.as_tensor(a)))
    def _A_setup():
        B, H, Sq, Sk, D, M = 1, 32, 1, 4096, 128, 640
        Dc = 4 * D
        return {
            "x": _w((lambda *s: torch.randn(*s, dtype=torch.bfloat16) * 3.2)(B, Sq, M)),
            "c_kv": _w((lambda *s: torch.randn(*s, dtype=torch.bfloat16) * 0.1)(B, Sk, Dc)),
            "w_q": _w((lambda *s: torch.randn(*s, dtype=torch.bfloat16) * 6.4)(M, H, D) * (M ** -0.5)),
            "w_uk": _w((lambda *s: torch.randn(*s, dtype=torch.bfloat16) * 6.4)(Dc, H, D) * (Dc ** -0.5)),
            "w_uv": _w((lambda *s: torch.randn(*s, dtype=torch.bfloat16) * 0.1)(Dc, H, D) * (Dc ** -0.5)),
            "w_o": _w((lambda *s: torch.randn(*s, dtype=torch.bfloat16) * 0.1)(H, D, M) * ((H * D) ** -0.5)),
        }
    _A_in = _A_setup()

    def _B_setup():
        B, Sq, D = 1, 1, 640
        H, Sk, Dh = 32, 4096, 128
        return {
            "x": _w((lambda *s: torch.randn(*s, dtype=torch.bfloat16) * 1.6)(B, Sq, D)),
            "k_cache": _w((lambda *s: torch.randn(*s, dtype=torch.bfloat16) * 1.6)(B, H, Sk, Dh)),
            "v_cache": _w((lambda *s: torch.randn(*s, dtype=torch.bfloat16) * 0.05)(B, H, Sk, Dh)),
            "wq": _w((lambda *s: torch.randn(*s, dtype=torch.bfloat16) * 1.6)(D, H * Dh) * (D ** -0.5)),
            "wo": _w((lambda *s: torch.randn(*s, dtype=torch.bfloat16) * 0.05)(H * Dh, D) * ((H * Dh) ** -0.5)),
        }
    _B_in = _B_setup()

    return {
        "A_x": _A_in["x"],
        "A_c_kv": _A_in["c_kv"],
        "A_w_q": _A_in["w_q"],
        "A_w_uk": _A_in["w_uk"],
        "A_w_uv": _A_in["w_uv"],
        "A_w_o": _A_in["w_o"],
        "B_x": _B_in["x"],
        "B_k_cache": _B_in["k_cache"],
        "B_v_cache": _B_in["v_cache"],
        "B_wq": _B_in["wq"],
        "B_wo": _B_in["wo"],
    }

def reference(A_x, A_c_kv, A_w_q, A_w_uk, A_w_uv, A_w_o, B_x, B_k_cache, B_v_cache, B_wq, B_wo):
    def _A_ref(x, c_kv, w_q, w_uk, w_uv, w_o):
        B, Sq, M = x.shape[0], x.shape[1], x.shape[2]
        Sk = c_kv.shape[1]
        H, D = w_q.shape[1], w_q.shape[2]
        q = torch.einsum("bqm,mhd->bhqd", x, w_q)
        k = torch.einsum("bkc,chd->bhkd", c_kv, w_uk)
        v = torch.einsum("bkc,chd->bhkd", c_kv, w_uv)
        scores = torch.einsum("bhqd,bhkd->bhqk", q, k) * (D ** -0.5)
        off = Sk - Sq
        qi = torch.arange(Sq)[:, None]
        kj = torch.arange(Sk)[None, :]
        cmask = kj <= (qi + off)
        scores = torch.where(cmask[None, None], scores, -1e9)
        p = _softmax(scores, axis=-1)
        ctx = torch.einsum("bhqk,bhkd->bhqd", p, v)
        return torch.einsum("bhqd,hdm->bqm", ctx, w_o)

    def _B_ref(x, k_cache, v_cache, wq, wo):
        B, Sq, D = x.shape
        H, Dh = 32, 128
        q = (lambda x, *d: x.permute(*d))((x @ wq).reshape(B, Sq, H, Dh), 0, 2, 1, 3)
        scores = torch.einsum("bhqd,bhkd->bhqk", q, k_cache) * (Dh ** -0.5)
        p = _softmax(scores, axis=-1)
        o = torch.einsum("bhqk,bhkd->bhqd", p, v_cache)
        return (lambda x, *d: x.permute(*d))(o, 0, 2, 1, 3).reshape(B, Sq, H * Dh) @ wo

    a = _A_ref(A_x, A_c_kv, A_w_q, A_w_uk, A_w_uv, A_w_o)
    b = _B_ref(B_x, B_k_cache, B_v_cache, B_wq, B_wo)
    return torch.concatenate([a, b], axis=-1)
```

```asm
; @launch grid=(256,1,1) block=(512,1,1) lds=163840
.amdgcn_target "amdgcn-amd-amdhsa--gfx950"
.text
.globl concat_heads__compressed_kv_cla__mha_block_cached__decode_kernel
.p2align 8
.type concat_heads__compressed_kv_cla__mha_block_cached__decode_kernel,@function
concat_heads__compressed_kv_cla__mha_block_cached__decode_kernel:
    s_cmp_ge_u32 s2, 256
    s_cbranch_scc1 L_end
    s_load_dwordx16 s[16:31], s[0:1], 0
    s_load_dwordx16 s[32:47], s[0:1], 48
    v_lshrrev_b32 v1, 6, v0
    v_and_b32 v0, 63, v0
    v_readfirstlane_b32 s3, v1
    v_lshrrev_b32 v1, 4, v0
    v_and_b32 v2, 15, v0
    s_cmp_lt_u32 s2, 64
    s_cbranch_scc1 L_A
    s_sub_u32 s7, s2, 64
    s_and_b32 s8, s7, 7
    s_lshr_b32 s7, s7, 3
    s_mul_i32 s9, s7, 43
    s_lshr_b32 s9, s9, 8
    s_mul_i32 s10, s9, 6
    s_sub_u32 s5, s7, s10
    s_lshl_b32 s8, s8, 2
    s_add_u32 s6, s8, s9
    v_lshlrev_b32 v25, 13, v1
    v_lshlrev_b32 v29, 4, v2
    v_add_u32 v25, v25, v29
    s_mul_i32 s7, s5, 80
    s_and_b32 s8, s3, 3
    s_mul_i32 s8, s8, 20
    s_add_u32 s7, s7, s8
    v_add_u32 v26, s7, v1
    v_lshlrev_b32 v26, 1, v26
    s_lshl_b32 s14, s7, 13
    s_lshl_b32 s8, s6, 8
    s_add_u32 s14, s14, s8
    s_waitcnt lgkmcnt(0)
    s_cmp_lt_u32 s3, 4
    s_cselect_b32 s68, s16, s32
    s_cselect_b32 s69, s17, s33
    s_cselect_b32 s8, s20, s38
    s_cselect_b32 s9, s21, s39
    s_mov_b32 s70, 1280
    s_mov_b32 s71, 0x20000
    s_add_u32 s60, s8, s14
    s_addc_u32 s61, s9, 0
    s_mov_b32 s62, 163840
    s_mov_b32 s63, 0x20000
    buffer_load_ushort v31, v26, s[68:71], 0 offen offset:0
    buffer_load_ushort v32, v26, s[68:71], 0 offen offset:8
    buffer_load_ushort v33, v26, s[68:71], 0 offen offset:16
    buffer_load_ushort v34, v26, s[68:71], 0 offen offset:24
    buffer_load_ushort v35, v26, s[68:71], 0 offen offset:32
    s_mov_b32 s7, 0
    buffer_load_dwordx4 v[236:239], v25, s[60:63], s7 offen nt
    s_mov_b32 s7, 32768
    buffer_load_dwordx4 v[240:243], v25, s[60:63], s7 offen nt
    s_mov_b32 s7, 65536
    buffer_load_dwordx4 v[244:247], v25, s[60:63], s7 offen nt
    s_mov_b32 s7, 98304
    buffer_load_dwordx4 v[248:251], v25, s[60:63], s7 offen nt
    s_mov_b32 s7, 131072
    buffer_load_dwordx4 v[252:255], v25, s[60:63], s7 offen nt
    s_load_dword s4, s[46:47], 0
    s_lshl_b32 s7, s3, 10
    v_lshlrev_b32 v28, 4, v0
    v_add_u32 v24, s7, v28
    s_lshl_b32 s9, s6, 20
    s_mul_i32 s10, s5, 175104
    s_add_u32 s9, s9, s10
    s_cmp_eq_u32 s5, 5
    s_mov_b32 s10, 175104
    s_cselect_b32 s10, 173056, s10
    s_add_u32 s52, s34, s9
    s_addc_u32 s53, s35, 0
    s_mov_b32 s54, s10
    s_mov_b32 s55, 0x20000
    s_add_u32 s56, s36, s9
    s_addc_u32 s57, s37, 0
    s_mov_b32 s58, s10
    s_mov_b32 s59, 0x20000
    s_mov_b32 s48, s46
    s_mov_b32 s49, s47
    s_mov_b32 s50, 3866624
    s_mov_b32 s51, 0x20000
    s_mul_i32 s9, s6, 163840
    s_lshl_b32 s10, s5, 8
    s_add_u32 s9, s9, s10
    s_add_u32 s64, s40, s9
    s_addc_u32 s65, s41, 0
    s_mov_b32 s66, 163840
    s_mov_b32 s67, 0x20000
    s_cmp_eq_u32 s5, 5
    s_cbranch_scc1 L_B5_0
    s_and_b32 s72, s6, 15
    s_lshl_b32 s72, s72, 13
    s_mov_b32 s73, s72
    buffer_load_dwordx4 v[64:67], v24, s[52:55], s72 offen nt
    s_addk_i32 s72, 0x2000
    s_cmp_eq_u32 s72, 180224
    s_cselect_b32 s72, 0, s72
    buffer_load_dwordx4 v[68:71], v24, s[52:55], s72 offen nt
    s_addk_i32 s72, 0x2000
    s_cmp_eq_u32 s72, 180224
    s_cselect_b32 s72, 0, s72
    v_lshrrev_b32 v3, 1, v2
    v_and_b32 v29, 1, v2
    v_lshlrev_b32 v29, 4, v29
    v_mov_b32 v30, 0xffff
    v_lshlrev_b32 v29, v29, v30
    v_cmp_eq_u32 vcc, 0, v3
    s_nop 1
    v_cndmask_b32 v4, 0, v29, vcc
    v_cmp_eq_u32 vcc, 1, v3
    s_nop 1
    v_cndmask_b32 v5, 0, v29, vcc
    v_cmp_eq_u32 vcc, 2, v3
    s_nop 1
    v_cndmask_b32 v6, 0, v29, vcc
    v_cmp_eq_u32 vcc, 3, v3
    s_nop 1
    v_cndmask_b32 v7, 0, v29, vcc
    s_lshl_b32 s9, s3, 9
    v_lshlrev_b32 v27, 5, v2
    v_lshlrev_b32 v30, 4, v1
    v_add3_u32 v27, v27, v30, s9
    s_waitcnt lgkmcnt(0)
    s_add_u32 s4, s4, 0x9e3779b1
    s_waitcnt vmcnt(6)
    v_lshl_or_b32 v31, v31, 16, v31
    v_and_b32 v16, v31, v4
    v_and_b32 v17, v31, v5
    v_and_b32 v18, v31, v6
    v_and_b32 v19, v31, v7
    s_nop 1
    v_mfma_f32_16x16x32_bf16 v[12:15], v[16:19], v[236:239], 0
    s_waitcnt vmcnt(5)
    v_lshl_or_b32 v32, v32, 16, v32
    v_and_b32 v20, v32, v4
    v_and_b32 v21, v32, v5
    v_and_b32 v22, v32, v6
    v_and_b32 v23, v32, v7
    s_nop 1
    v_mfma_f32_16x16x32_bf16 v[12:15], v[20:23], v[240:243], v[12:15]
    s_waitcnt vmcnt(4)
    v_lshl_or_b32 v33, v33, 16, v33
    v_and_b32 v16, v33, v4
    v_and_b32 v17, v33, v5
    v_and_b32 v18, v33, v6
    v_and_b32 v19, v33, v7
    s_nop 1
    v_mfma_f32_16x16x32_bf16 v[12:15], v[16:19], v[244:247], v[12:15]
    s_waitcnt vmcnt(3)
    v_lshl_or_b32 v34, v34, 16, v34
    v_and_b32 v20, v34, v4
    v_and_b32 v21, v34, v5
    v_and_b32 v22, v34, v6
    v_and_b32 v23, v34, v7
    s_nop 1
    v_mfma_f32_16x16x32_bf16 v[12:15], v[20:23], v[248:251], v[12:15]
    s_waitcnt vmcnt(2)
    v_lshl_or_b32 v35, v35, 16, v35
    v_and_b32 v16, v35, v4
    v_and_b32 v17, v35, v5
    v_and_b32 v18, v35, v6
    v_and_b32 v19, v35, v7
    s_nop 1
    v_mfma_f32_16x16x32_bf16 v[12:15], v[16:19], v[252:255], v[12:15]
    s_mov_b32 exec_lo, 0xffffffff
    s_mov_b32 exec_hi, 0x0
    s_nop 5
    ds_write_b128 v27, v[12:15] offset:0
    s_mov_b64 exec, -1
    s_waitcnt lgkmcnt(0)
    s_barrier
    s_and_b32 s7, s3, 3
    s_cmp_lg_u32 s7, 3
    s_cbranch_scc1 L_s1p_1
    s_setprio 2
    s_and_b32 s7, s3, 4
    s_lshl_b32 s7, s7, 9
    v_lshlrev_b32 v29, 3, v0
    v_add_u32 v29, s7, v29
    ds_read_b64 v[208:209], v29 offset:0
    ds_read_b64 v[210:211], v29 offset:512
    ds_read_b64 v[212:213], v29 offset:1024
    ds_read_b64 v[214:215], v29 offset:1536
    s_lshl_b32 s8, s6, 3
    s_add_u32 s8, s8, s5
    s_lshl_b32 s8, s8, 10
    s_cmp_eq_u32 s3, 3
    s_mov_b32 s9, 2359296
    s_cselect_b32 s9, 2621440, s9
    s_add_u32 s9, s9, s8
    v_mov_b32 v37, s4
    v_mov_b32 v39, s4
    s_waitcnt lgkmcnt(0)
    v_add_f32 v208, v208, v210
    v_add_f32 v209, v209, v211
    v_add_f32 v212, v212, v214
    v_add_f32 v213, v213, v215
    v_add_f32 v36, v208, v212
    v_add_f32 v38, v209, v213
    s_cmp_eq_u32 s3, 3
    s_mov_b32 s7, 3604480
    s_cselect_b32 s7, 2883584, s7
    s_add_u32 s8, s8, s7
    buffer_store_dwordx4 v[36:39], v28, s[48:51], s8 offen
    buffer_store_dwordx4 v[36:39], v28, s[48:51], s9 offen sc1
    s_setprio 0
    s_nop 0
L_s1p_1:
    buffer_load_dwordx4 v[72:75], v24, s[52:55], s72 offen nt
    s_addk_i32 s72, 0x2000
    s_cmp_eq_u32 s72, 180224
    s_cselect_b32 s72, 0, s72
    s_waitcnt vmcnt(2)
    buffer_load_dwordx4 v[76:79], v24, s[52:55], s72 offen nt
    s_addk_i32 s72, 0x2000
    s_cmp_eq_u32 s72, 180224
    s_cselect_b32 s72, 0, s72
    s_waitcnt vmcnt(2)
    buffer_load_dwordx4 v[80:83], v24, s[52:55], s72 offen nt
    s_addk_i32 s72, 0x2000
    s_cmp_eq_u32 s72, 180224
    s_cselect_b32 s72, 0, s72
    s_waitcnt vmcnt(2)
    buffer_load_dwordx4 v[84:87], v24, s[52:55], s72 offen nt
    s_addk_i32 s72, 0x2000
    s_cmp_eq_u32 s72, 180224
    s_cselect_b32 s72, 0, s72
    s_waitcnt vmcnt(2)
    buffer_load_dwordx4 v[88:91], v24, s[52:55], s72 offen nt
    s_addk_i32 s72, 0x2000
    s_cmp_eq_u32 s72, 180224
    s_cselect_b32 s72, 0, s72
    s_waitcnt vmcnt(2)
    buffer_load_dwordx4 v[92:95], v24, s[52:55], s72 offen nt
    s_addk_i32 s72, 0x2000
    s_cmp_eq_u32 s72, 180224
    s_cselect_b32 s72, 0, s72
    s_waitcnt vmcnt(2)
    buffer_load_dwordx4 v[96:99], v24, s[52:55], s72 offen nt
    s_addk_i32 s72, 0x2000
    s_cmp_eq_u32 s72, 180224
    s_cselect_b32 s72, 0, s72
    s_cmp_lg_u32 s3, 0
    s_cbranch_scc1 L_nc_2
    s_mov_b32 s15, 0
    s_cmp_lt_u32 s15, 64
    s_mov_b32 s9, 2359296
    s_cselect_b32 s9, 3604480, s9
    s_lshl_b32 s8, s6, 13
    s_add_u32 s8, s8, s9
    buffer_load_dwordx4 v[208:211], v28, s[48:51], s8 offen sc1
    s_addk_i32 s8, 0x400
    buffer_load_dwordx4 v[212:215], v28, s[48:51], s8 offen sc1
    s_addk_i32 s8, 0x400
    buffer_load_dwordx4 v[216:219], v28, s[48:51], s8 offen sc1
    s_addk_i32 s8, 0x400
    buffer_load_dwordx4 v[220:223], v28, s[48:51], s8 offen sc1
    s_addk_i32 s8, 0x400
    buffer_load_dwordx4 v[224:227], v28, s[48:51], s8 offen sc1
    s_addk_i32 s8, 0x400
    buffer_load_dwordx4 v[228:231], v28, s[48:51], s8 offen sc1
    s_addk_i32 s8, 0x400
    buffer_load_dwordx4 v[232:235], v28, s[48:51], s8 offen sc1
    s_addk_i32 s8, 0x400
    buffer_load_dwordx4 v[236:239], v28, s[48:51], s8 offen sc1
L_nc_2:
    s_waitcnt vmcnt(2)
    buffer_load_dwordx4 v[100:103], v24, s[52:55], s72 offen nt
    s_addk_i32 s72, 0x2000
    s_cmp_eq_u32 s72, 180224
    s_cselect_b32 s72, 0, s72
    s_waitcnt vmcnt(2)
    buffer_load_dwordx4 v[104:107], v24, s[52:55], s72 offen nt
    s_addk_i32 s72, 0x2000
    s_cmp_eq_u32 s72, 180224
    s_cselect_b32 s72, 0, s72
    s_waitcnt vmcnt(2)
    buffer_load_dwordx4 v[108:111], v24, s[52:55], s72 offen nt
    s_addk_i32 s72, 0x2000
    s_cmp_eq_u32 s72, 180224
    s_cselect_b32 s72, 0, s72
    s_waitcnt vmcnt(2)
    buffer_load_dwordx4 v[112:115], v24, s[52:55], s72 offen nt
    s_addk_i32 s72, 0x2000
    s_cmp_eq_u32 s72, 180224
    s_cselect_b32 s72, 0, s72
    s_waitcnt vmcnt(2)
    buffer_load_dwordx4 v[116:119], v24, s[52:55], s72 offen nt
    s_addk_i32 s72, 0x2000
    s_cmp_eq_u32 s72, 180224
    s_cselect_b32 s72, 0, s72
    s_waitcnt vmcnt(2)
    buffer_load_dwordx4 v[120:123], v24, s[52:55], s72 offen nt
    s_addk_i32 s72, 0x2000
    s_cmp_eq_u32 s72, 180224
    s_cselect_b32 s72, 0, s72
    s_waitcnt vmcnt(2)
    buffer_load_dwordx4 v[124:127], v24, s[52:55], s72 offen nt
    s_addk_i32 s72, 0x2000
    s_cmp_eq_u32 s72, 180224
    s_cselect_b32 s72, 0, s72
    s_waitcnt vmcnt(2)
    buffer_load_dwordx4 v[128:131], v24, s[52:55], s72 offen nt
    s_addk_i32 s72, 0x2000
    s_cmp_eq_u32 s72, 180224
    s_cselect_b32 s72, 0, s72
    s_waitcnt vmcnt(2)
    buffer_load_dwordx4 v[132:135], v24, s[52:55], s72 offen nt
    s_addk_i32 s72, 0x2000
    s_cmp_eq_u32 s72, 180224
    s_cselect_b32 s72, 0, s72
    s_waitcnt vmcnt(2)
    buffer_load_dwordx4 v[136:139], v24, s[52:55], s72 offen nt
    s_addk_i32 s72, 0x2000
    s_cmp_eq_u32 s72, 180224
    s_cselect_b32 s72, 0, s72
    s_waitcnt vmcnt(2)
    buffer_load_dwordx4 v[140:143], v24, s[52:55], s72 offen nt
    s_addk_i32 s72, 0x2000
    s_cmp_eq_u32 s72, 180224
    s_cselect_b32 s72, 0, s72
    s_waitcnt vmcnt(2)
    buffer_load_dwordx4 v[144:147], v24, s[52:55], s72 offen nt
    s_addk_i32 s72, 0x2000
    s_cmp_eq_u32 s72, 180224
    s_cselect_b32 s72, 0, s72
    s_waitcnt vmcnt(2)
    buffer_load_dwordx4 v[148:151], v24, s[52:55], s72 offen nt
    s_addk_i32 s72, 0x2000
    s_cmp_eq_u32 s72, 180224
    s_cselect_b32 s72, 0, s72
    s_waitcnt vmcnt(2)
    buffer_load_dwordx4 v[152:155], v24, s[56:59], s73 offen nt
    s_addk_i32 s73, 0x2000
    s_cmp_eq_u32 s73, 180224
    s_cselect_b32 s73, 0, s73
    s_waitcnt vmcnt(2)
    buffer_load_dwordx4 v[156:159], v24, s[56:59], s73 offen nt
    s_addk_i32 s73, 0x2000
    s_cmp_eq_u32 s73, 180224
    s_cselect_b32 s73, 0, s73
    s_cmp_lg_u32 s3, 0
    s_cbranch_scc1 L_nc_3
    s_setprio 2
L_qchk_4:
    v_xor_b32 v209, s4, v209
    v_xor_b32 v211, s4, v211
    v_or_b32 v29, v209, v211
    v_xor_b32 v213, s4, v213
    v_xor_b32 v215, s4, v215
    v_or3_b32 v29, v29, v213, v215
    v_xor_b32 v217, s4, v217
    v_xor_b32 v219, s4, v219
    v_or3_b32 v29, v29, v217, v219
    v_xor_b32 v221, s4, v221
    v_xor_b32 v223, s4, v223
    v_or3_b32 v29, v29, v221, v223
    v_xor_b32 v225, s4, v225
    v_xor_b32 v227, s4, v227
    v_or3_b32 v29, v29, v225, v227
    v_xor_b32 v229, s4, v229
    v_xor_b32 v231, s4, v231
    v_or3_b32 v29, v29, v229, v231
    v_xor_b32 v233, s4, v233
    v_xor_b32 v235, s4, v235
    v_or3_b32 v29, v29, v233, v235
    v_xor_b32 v237, s4, v237
    v_xor_b32 v239, s4, v239
    v_or3_b32 v29, v29, v237, v239
    v_cmp_ne_u32 vcc, 0, v29
    s_nop 0
    s_cmp_eq_u64 vcc, 0
    s_nop 2
    s_cbranch_scc1 L_qdone_5
    s_add_u32 s15, s15, 1
    s_cmp_gt_u32 s15, 200000
    s_cbranch_scc1 L_qdone_5
    s_cmp_lt_u32 s15, 64
    s_mov_b32 s9, 2359296
    s_cselect_b32 s9, 3604480, s9
    s_lshl_b32 s8, s6, 13
    s_add_u32 s8, s8, s9
    buffer_load_dwordx4 v[208:211], v28, s[48:51], s8 offen sc1
    s_addk_i32 s8, 0x400
    buffer_load_dwordx4 v[212:215], v28, s[48:51], s8 offen sc1
    s_addk_i32 s8, 0x400
    buffer_load_dwordx4 v[216:219], v28, s[48:51], s8 offen sc1
    s_addk_i32 s8, 0x400
    buffer_load_dwordx4 v[220:223], v28, s[48:51], s8 offen sc1
    s_addk_i32 s8, 0x400
    buffer_load_dwordx4 v[224:227], v28, s[48:51], s8 offen sc1
    s_addk_i32 s8, 0x400
    buffer_load_dwordx4 v[228:231], v28, s[48:51], s8 offen sc1
    s_addk_i32 s8, 0x400
    buffer_load_dwordx4 v[232:235], v28, s[48:51], s8 offen sc1
    s_addk_i32 s8, 0x400
    buffer_load_dwordx4 v[236:239], v28, s[48:51], s8 offen sc1
    s_waitcnt vmcnt(0)
    s_branch L_qchk_4
L_qdone_5:
    v_add_f32 v208, v208, v212
    v_add_f32 v210, v210, v214
    v_add_f32 v216, v216, v220
    v_add_f32 v218, v218, v222
    v_add_f32 v224, v224, v228
    v_add_f32 v226, v226, v230
    v_add_f32 v232, v232, v236
    v_add_f32 v234, v234, v238
    v_add_f32 v208, v208, v216
    v_add_f32 v210, v210, v218
    v_add_f32 v224, v224, v232
    v_add_f32 v226, v226, v234
    v_add_f32 v208, v208, v224
    v_add_f32 v210, v210, v226
    v_cvt_pk_bf16_f32 v208, v208, v210
    v_lshlrev_b32 v29, 2, v0
    v_add_u32 v29, 12288, v29
    ds_write_b32 v29, v208
    s_waitcnt lgkmcnt(0)
    s_setprio 0
L_nc_3:
    s_barrier
    v_lshlrev_b32 v29, 4, v2
    ds_read_b128 v[8:11], v29 offset:12288
    s_waitcnt lgkmcnt(0)
    buffer_load_dwordx4 v[160:163], v24, s[56:59], s73 offen nt
    s_addk_i32 s73, 0x2000
    s_cmp_eq_u32 s73, 180224
    s_cselect_b32 s73, 0, s73
    v_dot2_f32_bf16 v64, v64, v8, 0
    v_dot2_f32_bf16 v68, v68, v8, 0
    v_dot2_f32_bf16 v72, v72, v8, 0
    v_dot2_f32_bf16 v76, v76, v8, 0
    v_dot2_f32_bf16 v64, v65, v9, v64
    v_dot2_f32_bf16 v68, v69, v9, v68
    v_dot2_f32_bf16 v72, v73, v9, v72
    v_dot2_f32_bf16 v76, v77, v9, v76
    v_dot2_f32_bf16 v64, v66, v10, v64
    v_dot2_f32_bf16 v68, v70, v10, v68
    v_dot2_f32_bf16 v72, v74, v10, v72
    v_dot2_f32_bf16 v76, v78, v10, v76
    v_dot2_f32_bf16 v64, v67, v11, v64
    v_dot2_f32_bf16 v68, v71, v11, v68
    v_dot2_f32_bf16 v72, v75, v11, v72
    v_dot2_f32_bf16 v76, v79, v11, v76
    v_dot2_f32_bf16 v80, v80, v8, 0
    v_dot2_f32_bf16 v84, v84, v8, 0
    v_dot2_f32_bf16 v88, v88, v8, 0
    v_dot2_f32_bf16 v92, v92, v8, 0
    v_dot2_f32_bf16 v80, v81, v9, v80
    v_dot2_f32_bf16 v84, v85, v9, v84
    v_dot2_f32_bf16 v88, v89, v9, v88
    v_dot2_f32_bf16 v92, v93, v9, v92
    v_dot2_f32_bf16 v80, v82, v10, v80
    v_dot2_f32_bf16 v84, v86, v10, v84
    v_dot2_f32_bf16 v88, v90, v10, v88
    v_dot2_f32_bf16 v92, v94, v10, v92
    v_dot2_f32_bf16 v80, v83, v11, v80
    v_dot2_f32_bf16 v84, v87, v11, v84
    v_dot2_f32_bf16 v88, v91, v11, v88
    v_dot2_f32_bf16 v92, v95, v11, v92
    v_dot2_f32_bf16 v96, v96, v8, 0
    v_dot2_f32_bf16 v100, v100, v8, 0
    v_dot2_f32_bf16 v104, v104, v8, 0
    v_dot2_f32_bf16 v108, v108, v8, 0
    v_dot2_f32_bf16 v96, v97, v9, v96
    v_dot2_f32_bf16 v100, v101, v9, v100
    v_dot2_f32_bf16 v104, v105, v9, v104
    v_dot2_f32_bf16 v108, v109, v9, v108
    v_dot2_f32_bf16 v96, v98, v10, v96
    v_dot2_f32_bf16 v100, v102, v10, v100
    v_dot2_f32_bf16 v104, v106, v10, v104
    v_dot2_f32_bf16 v108, v110, v10, v108
    v_dot2_f32_bf16 v96, v99, v11, v96
    v_dot2_f32_bf16 v100, v103, v11, v100
    v_dot2_f32_bf16 v104, v107, v11, v104
    v_dot2_f32_bf16 v108, v111, v11, v108
    buffer_load_dwordx4 v[164:167], v24, s[56:59], s73 offen nt
    s_addk_i32 s73, 0x2000
    s_cmp_eq_u32 s73, 180224
    s_cselect_b32 s73, 0, s73
    v_dot2_f32_bf16 v112, v112, v8, 0
    v_dot2_f32_bf16 v116, v116, v8, 0
    v_dot2_f32_bf16 v120, v120, v8, 0
    v_dot2_f32_bf16 v124, v124, v8, 0
    v_dot2_f32_bf16 v112, v113, v9, v112
    v_dot2_f32_bf16 v116, v117, v9, v116
    v_dot2_f32_bf16 v120, v121, v9, v120
    v_dot2_f32_bf16 v124, v125, v9, v124
    v_dot2_f32_bf16 v112, v114, v10, v112
    v_dot2_f32_bf16 v116, v118, v10, v116
    v_dot2_f32_bf16 v120, v122, v10, v120
    v_dot2_f32_bf16 v124, v126, v10, v124
    v_dot2_f32_bf16 v112, v115, v11, v112
    v_dot2_f32_bf16 v116, v119, v11, v116
    v_dot2_f32_bf16 v120, v123, v11, v120
    v_dot2_f32_bf16 v124, v127, v11, v124
    v_dot2_f32_bf16 v128, v128, v8, 0
    v_dot2_f32_bf16 v132, v132, v8, 0
    v_dot2_f32_bf16 v136, v136, v8, 0
    v_dot2_f32_bf16 v140, v140, v8, 0
    v_dot2_f32_bf16 v128, v129, v9, v128
    v_dot2_f32_bf16 v132, v133, v9, v132
    v_dot2_f32_bf16 v136, v137, v9, v136
    v_dot2_f32_bf16 v140, v141, v9, v140
    v_dot2_f32_bf16 v128, v130, v10, v128
    v_dot2_f32_bf16 v132, v134, v10, v132
    v_dot2_f32_bf16 v136, v138, v10, v136
    v_dot2_f32_bf16 v140, v142, v10, v140
    v_dot2_f32_bf16 v128, v131, v11, v128
    v_dot2_f32_bf16 v132, v135, v11, v132
    v_dot2_f32_bf16 v136, v139, v11, v136
    v_dot2_f32_bf16 v140, v143, v11, v140
    s_waitcnt vmcnt(4)
    v_dot2_f32_bf16 v144, v144, v8, 0
    v_dot2_f32_bf16 v148, v148, v8, 0
    v_dot2_f32_bf16 v144, v145, v9, v144
    v_dot2_f32_bf16 v148, v149, v9, v148
    v_dot2_f32_bf16 v144, v146, v10, v144
    v_dot2_f32_bf16 v148, v150, v10, v148
    v_dot2_f32_bf16 v144, v147, v11, v144
    v_dot2_f32_bf16 v148, v151, v11, v148
    v_add_f32_dpp v64, v64, v64 row_ror:8 row_mask:0xf bank_mask:0x3
    v_add_f32_dpp v68, v68, v68 row_ror:8 row_mask:0xf bank_mask:0x3
    v_add_f32_dpp v72, v72, v72 row_ror:8 row_mask:0xf bank_mask:0x3
    v_add_f32_dpp v76, v76, v76 row_ror:8 row_mask:0xf bank_mask:0x3
    v_add_f32_dpp v80, v80, v80 row_ror:8 row_mask:0xf bank_mask:0x3
    v_add_f32_dpp v84, v84, v84 row_ror:8 row_mask:0xf bank_mask:0x3
    v_add_f32_dpp v88, v88, v88 row_ror:8 row_mask:0xf bank_mask:0x3
    v_add_f32_dpp v92, v92, v92 row_ror:8 row_mask:0xf bank_mask:0x3
    v_add_f32_dpp v64, v96, v96 row_ror:8 row_mask:0xf bank_mask:0xc
    v_add_f32_dpp v68, v100, v100 row_ror:8 row_mask:0xf bank_mask:0xc
    v_add_f32_dpp v72, v104, v104 row_ror:8 row_mask:0xf bank_mask:0xc
    v_add_f32_dpp v76, v108, v108 row_ror:8 row_mask:0xf bank_mask:0xc
    v_add_f32_dpp v80, v112, v112 row_ror:8 row_mask:0xf bank_mask:0xc
    v_add_f32_dpp v84, v116, v116 row_ror:8 row_mask:0xf bank_mask:0xc
    v_add_f32_dpp v88, v120, v120 row_ror:8 row_mask:0xf bank_mask:0xc
    v_add_f32_dpp v92, v124, v124 row_ror:8 row_mask:0xf bank_mask:0xc
    v_add_f32_dpp v64, v64, v64 row_half_mirror row_mask:0xf bank_mask:0x5
    v_add_f32_dpp v68, v68, v68 row_half_mirror row_mask:0xf bank_mask:0x5
    v_add_f32_dpp v72, v72, v72 row_half_mirror row_mask:0xf bank_mask:0x5
    v_add_f32_dpp v76, v76, v76 row_half_mirror row_mask:0xf bank_mask:0x5
    v_add_f32_dpp v64, v80, v80 row_half_mirror row_mask:0xf bank_mask:0xa
    v_add_f32_dpp v68, v84, v84 row_half_mirror row_mask:0xf bank_mask:0xa
    v_add_f32_dpp v72, v88, v88 row_half_mirror row_mask:0xf bank_mask:0xa
    v_add_f32_dpp v76, v92, v92 row_half_mirror row_mask:0xf bank_mask:0xa
    v_add_f32_dpp v64, v64, v64 quad_perm:[2,3,0,1] row_mask:0xf bank_mask:0xf
    v_add_f32_dpp v68, v68, v68 quad_perm:[2,3,0,1] row_mask:0xf bank_mask:0xf
    v_add_f32_dpp v72, v72, v72 quad_perm:[2,3,0,1] row_mask:0xf bank_mask:0xf
    v_add_f32_dpp v76, v76, v76 quad_perm:[2,3,0,1] row_mask:0xf bank_mask:0xf
    s_mov_b32 s8, 0xcccccccc
    s_mov_b32 s9, 0xcccccccc
    s_mov_b32 s10, 0xaaaaaaaa
    s_mov_b32 s11, 0xaaaaaaaa
    v_cndmask_b32 v64, v64, v72, s[8:9]
    v_cndmask_b32 v68, v68, v76, s[8:9]
    s_nop 0
    v_add_f32_dpp v64, v64, v64 quad_perm:[1,0,3,2] row_mask:0xf bank_mask:0xf
    v_add_f32_dpp v68, v68, v68 quad_perm:[1,0,3,2] row_mask:0xf bank_mask:0xf
    v_cndmask_b32 v40, v64, v68, s[10:11]
    buffer_load_dwordx4 v[168:171], v24, s[56:59], s73 offen nt
    s_addk_i32 s73, 0x2000
    s_cmp_eq_u32 s73, 180224
    s_cselect_b32 s73, 0, s73
    v_add_f32_dpp v128, v128, v128 row_ror:8 row_mask:0xf bank_mask:0x3
    v_add_f32_dpp v132, v132, v132 row_ror:8 row_mask:0xf bank_mask:0x3
    v_add_f32_dpp v136, v136, v136 row_ror:8 row_mask:0xf bank_mask:0x3
    v_add_f32_dpp v140, v140, v140 row_ror:8 row_mask:0xf bank_mask:0x3
    v_add_f32_dpp v144, v144, v144 row_ror:8 row_mask:0xf bank_mask:0x3
    v_add_f32_dpp v148, v148, v148 row_ror:8 row_mask:0xf bank_mask:0x3
    v_add_f32_dpp v128, v128, v128 row_half_mirror row_mask:0xf bank_mask:0x5
    v_add_f32_dpp v132, v132, v132 row_half_mirror row_mask:0xf bank_mask:0x5
    v_add_f32_dpp v136, v136, v136 row_half_mirror row_mask:0xf bank_mask:0x5
    v_add_f32_dpp v140, v140, v140 row_half_mirror row_mask:0xf bank_mask:0x5
    v_add_f32_dpp v128, v144, v144 row_half_mirror row_mask:0xf bank_mask:0xa
    v_add_f32_dpp v132, v148, v148 row_half_mirror row_mask:0xf bank_mask:0xa
    s_nop 0
    v_add_f32_dpp v128, v128, v128 quad_perm:[2,3,0,1] row_mask:0xf bank_mask:0xf
    v_add_f32_dpp v132, v132, v132 quad_perm:[2,3,0,1] row_mask:0xf bank_mask:0xf
    v_add_f32_dpp v136, v136, v136 quad_perm:[2,3,0,1] row_mask:0xf bank_mask:0xf
    v_add_f32_dpp v140, v140, v140 quad_perm:[2,3,0,1] row_mask:0xf bank_mask:0xf
    s_mov_b32 s8, 0xcccccccc
    s_mov_b32 s9, 0xcccccccc
    s_mov_b32 s10, 0xaaaaaaaa
    s_mov_b32 s11, 0xaaaaaaaa
    v_cndmask_b32 v128, v128, v136, s[8:9]
    v_cndmask_b32 v132, v132, v140, s[8:9]
    s_nop 0
    v_add_f32_dpp v128, v128, v128 quad_perm:[1,0,3,2] row_mask:0xf bank_mask:0xf
    v_add_f32_dpp v132, v132, v132 quad_perm:[1,0,3,2] row_mask:0xf bank_mask:0xf
    v_cndmask_b32 v41, v128, v132, s[10:11]
    s_mov_b32 s7, 0x3e0293ee
    v_mul_f32 v40, s7, v40
    v_mul_f32 v41, s7, v41
    v_mov_b32 v29, 0xff800000
    s_and_b32 s8, s6, 15
    s_sub_u32 s8, 21, s8
    s_cmp_lt_u32 s3, 3
    s_cselect_b32 s8, 63, s8
    v_cmp_ne_u32 vcc, s8, v2
    s_nop 1
    v_cndmask_b32 v40, v29, v40, vcc
    s_sub_u32 s8, s8, 16
    v_cmp_ne_u32 vcc, s8, v2
    s_nop 1
    v_cndmask_b32 v41, v29, v41, vcc
    v_cmp_gt_u32 vcc, 6, v2
    s_nop 1
    v_cndmask_b32 v41, v29, v41, vcc
    v_max_f32 v44, v40, v41
    s_nop 1
    v_max_f32_dpp v44, v44, v44 row_ror:8 row_mask:0xf bank_mask:0xf
    s_nop 1
    v_max_f32_dpp v44, v44, v44 row_ror:4 row_mask:0xf bank_mask:0xf
    s_nop 1
    v_max_f32_dpp v44, v44, v44 row_ror:2 row_mask:0xf bank_mask:0xf
    s_nop 1
    v_max_f32_dpp v44, v44, v44 row_ror:1 row_mask:0xf bank_mask:0xf
    v_mov_b32 v29, v44
    s_nop 1
    v_permlane16_swap_b32 v44, v29
    v_max_f32 v44, v44, v29
    v_mov_b32 v29, v44
    s_nop 1
    v_permlane32_swap_b32 v44, v29
    v_max_f32 v44, v44, v29
    v_sub_f32 v40, v40, v44
    v_sub_f32 v41, v41, v44
    v_exp_f32 v40, v40
    v_exp_f32 v41, v41
    v_cvt_pk_bf16_f32 v42, v40, v40
    v_cvt_pk_bf16_f32 v43, v41, v41
    v_lshlrev_b32 v40, 16, v42
    v_lshlrev_b32 v41, 16, v43
    v_add_f32 v45, v40, v41
    s_nop 1
    v_add_f32_dpp v45, v45, v45 row_ror:8 row_mask:0xf bank_mask:0xf
    s_nop 1
    v_add_f32_dpp v45, v45, v45 row_ror:4 row_mask:0xf bank_mask:0xf
    s_nop 1
    v_add_f32_dpp v45, v45, v45 row_ror:2 row_mask:0xf bank_mask:0xf
    s_nop 1
    v_add_f32_dpp v45, v45, v45 row_ror:1 row_mask:0xf bank_mask:0xf
    v_mov_b32 v29, v45
    s_nop 1
    v_permlane16_swap_b32 v45, v29
    v_add_f32 v45, v45, v29
    v_mov_b32 v29, v45
    s_nop 1
    v_permlane32_swap_b32 v45, v29
    v_add_f32 v45, v45, v29
    s_lshl_b32 s7, s3, 3
    v_mov_b32 v29, s7
    s_mov_b32 exec_lo, 0x1
    s_mov_b32 exec_hi, 0x0
    ds_write_b64 v29, v[44:45] offset:12544
    s_mov_b64 exec, -1
    s_waitcnt lgkmcnt(0)
    s_barrier
    s_cmp_lg_u32 s3, 0
    s_cbranch_scc1 L_nc_6
    s_setprio 2
    v_and_b32 v29, 7, v0
    v_lshlrev_b32 v30, 3, v29
    ds_read_b64 v[32:33], v30 offset:12544
    s_waitcnt lgkmcnt(0)
    v_mov_b32 v47, v32
    v_mov_b32 v34, v32
    s_nop 1
    v_max_f32_dpp v34, v34, v34 row_ror:4 row_mask:0xf bank_mask:0xf
    s_nop 1
    v_max_f32_dpp v34, v34, v34 row_ror:2 row_mask:0xf bank_mask:0xf
    s_nop 1
    v_max_f32_dpp v34, v34, v34 row_ror:1 row_mask:0xf bank_mask:0xf
    v_sub_f32 v35, v32, v34
    v_exp_f32 v35, v35
    s_nop 0
    v_mul_f32 v35, v35, v33
    s_nop 1
    v_add_f32_dpp v35, v35, v35 row_ror:4 row_mask:0xf bank_mask:0xf
    s_nop 1
    v_add_f32_dpp v35, v35, v35 row_ror:2 row_mask:0xf bank_mask:0xf
    s_nop 1
    v_add_f32_dpp v35, v35, v35 row_ror:1 row_mask:0xf bank_mask:0xf
    v_mov_b32 v36, v34
    v_mov_b32 v37, s4
    v_mov_b32 v38, v35
    v_mov_b32 v39, s4
    s_lshl_b32 s8, s6, 7
    s_add_u32 s8, s8, 4096
    s_lshl_b32 s9, s5, 4
    s_add_u32 s9, s9, s8
    v_mov_b32 v30, 0
    s_mov_b32 exec_lo, 0x1
    s_mov_b32 exec_hi, 0x0
    buffer_store_dwordx4 v[36:39], v30, s[48:51], s9 offen sc1
    s_mov_b64 exec, -1
    s_setprio 0
L_nc_6:
    v_and_b32_dpp v16, v42, v4 row_newbcast:0 row_mask:0xf bank_mask:0xf
    v_and_b32_dpp v17, v42, v5 row_newbcast:0 row_mask:0xf bank_mask:0xf
    v_and_b32_dpp v18, v42, v6 row_newbcast:0 row_mask:0xf bank_mask:0xf
    v_and_b32_dpp v19, v42, v7 row_newbcast:0 row_mask:0xf bank_mask:0xf
    s_waitcnt vmcnt(4)
    s_nop 0
    v_mfma_f32_16x16x32_bf16 v[12:15], v[16:19], v[152:155], 0
    v_and_b32_dpp v20, v42, v4 row_newbcast:1 row_mask:0xf bank_mask:0xf
    v_and_b32_dpp v21, v42, v5 row_newbcast:1 row_mask:0xf bank_mask:0xf
    v_and_b32_dpp v22, v42, v6 row_newbcast:1 row_mask:0xf bank_mask:0xf
    v_and_b32_dpp v23, v42, v7 row_newbcast:1 row_mask:0xf bank_mask:0xf
    s_waitcnt vmcnt(3)
    s_nop 0
    v_mfma_f32_16x16x32_bf16 v[12:15], v[20:23], v[156:159], v[12:15]
    v_and_b32_dpp v16, v42, v4 row_newbcast:2 row_mask:0xf bank_mask:0xf
    v_and_b32_dpp v17, v42, v5 row_newbcast:2 row_mask:0xf bank_mask:0xf
    v_and_b32_dpp v18, v42, v6 row_newbcast:2 row_mask:0xf bank_mask:0xf
    v_and_b32_dpp v19, v42, v7 row_newbcast:2 row_mask:0xf bank_mask:0xf
    buffer_load_dwordx4 v[172:175], v24, s[56:59], s73 offen nt
    s_addk_i32 s73, 0x2000
    s_cmp_eq_u32 s73, 180224
    s_cselect_b32 s73, 0, s73
    s_waitcnt vmcnt(3)
    v_mfma_f32_16x16x32_bf16 v[12:15], v[16:19], v[160:163], v[12:15]
    v_and_b32_dpp v20, v42, v4 row_newbcast:3 row_mask:0xf bank_mask:0xf
    v_and_b32_dpp v21, v42, v5 row_newbcast:3 row_mask:0xf bank_mask:0xf
    v_and_b32_dpp v22, v42, v6 row_newbcast:3 row_mask:0xf bank_mask:0xf
    v_and_b32_dpp v23, v42, v7 row_newbcast:3 row_mask:0xf bank_mask:0xf
    buffer_load_dwordx4 v[176:179], v24, s[56:59], s73 offen nt
    s_addk_i32 s73, 0x2000
    s_cmp_eq_u32 s73, 180224
    s_cselect_b32 s73, 0, s73
    s_waitcnt vmcnt(3)
    v_mfma_f32_16x16x32_bf16 v[12:15], v[20:23], v[164:167], v[12:15]
    v_and_b32_dpp v16, v42, v4 row_newbcast:4 row_mask:0xf bank_mask:0xf
    v_and_b32_dpp v17, v42, v5 row_newbcast:4 row_mask:0xf bank_mask:0xf
    v_and_b32_dpp v18, v42, v6 row_newbcast:4 row_mask:0xf bank_mask:0xf
    v_and_b32_dpp v19, v42, v7 row_newbcast:4 row_mask:0xf bank_mask:0xf
    buffer_load_dwordx4 v[180:183], v24, s[56:59], s73 offen nt
    s_addk_i32 s73, 0x2000
    s_cmp_eq_u32 s73, 180224
    s_cselect_b32 s73, 0, s73
    s_waitcnt vmcnt(3)
    v_mfma_f32_16x16x32_bf16 v[12:15], v[16:19], v[168:171], v[12:15]
    v_and_b32_dpp v20, v42, v4 row_newbcast:5 row_mask:0xf bank_mask:0xf
    v_and_b32_dpp v21, v42, v5 row_newbcast:5 row_mask:0xf bank_mask:0xf
    v_and_b32_dpp v22, v42, v6 row_newbcast:5 row_mask:0xf bank_mask:0xf
    v_and_b32_dpp v23, v42, v7 row_newbcast:5 row_mask:0xf bank_mask:0xf
    buffer_load_dwordx4 v[184:187], v24, s[56:59], s73 offen nt
    s_addk_i32 s73, 0x2000
    s_cmp_eq_u32 s73, 180224
    s_cselect_b32 s73, 0, s73
    s_waitcnt vmcnt(3)
    v_mfma_f32_16x16x32_bf16 v[12:15], v[20:23], v[172:175], v[12:15]
    v_and_b32_dpp v16, v42, v4 row_newbcast:6 row_mask:0xf bank_mask:0xf
    v_and_b32_dpp v17, v42, v5 row_newbcast:6 row_mask:0xf bank_mask:0xf
    v_and_b32_dpp v18, v42, v6 row_newbcast:6 row_mask:0xf bank_mask:0xf
    v_and_b32_dpp v19, v42, v7 row_newbcast:6 row_mask:0xf bank_mask:0xf
    buffer_load_dwordx4 v[188:191], v24, s[56:59], s73 offen nt
    s_addk_i32 s73, 0x2000
    s_cmp_eq_u32 s73, 180224
    s_cselect_b32 s73, 0, s73
    s_waitcnt vmcnt(3)
    v_mfma_f32_16x16x32_bf16 v[12:15], v[16:19], v[176:179], v[12:15]
    v_and_b32_dpp v20, v42, v4 row_newbcast:7 row_mask:0xf bank_mask:0xf
    v_and_b32_dpp v21, v42, v5 row_newbcast:7 row_mask:0xf bank_mask:0xf
    v_and_b32_dpp v22, v42, v6 row_newbcast:7 row_mask:0xf bank_mask:0xf
    v_and_b32_dpp v23, v42, v7 row_newbcast:7 row_mask:0xf bank_mask:0xf
    s_cmp_lg_u32 s3, 0
    s_nop 2
    s_cbranch_scc1 L_nc_7
    v_and_b32 v29, 7, v0
    v_min_u32 v29, 5, v29
    v_lshlrev_b32 v29, 4, v29
    s_lshl_b32 s8, s6, 7
    s_add_u32 s8, s8, 4096
    buffer_load_dwordx4 v[36:39], v29, s[48:51], s8 offen sc1
L_nc_7:
    buffer_load_dwordx4 v[192:195], v24, s[56:59], s73 offen nt
    s_addk_i32 s73, 0x2000
    s_cmp_eq_u32 s73, 180224
    s_cselect_b32 s73, 0, s73
    s_waitcnt vmcnt(3)
    v_mfma_f32_16x16x32_bf16 v[12:15], v[20:23], v[180:183], v[12:15]
    v_and_b32_dpp v16, v42, v4 row_newbcast:8 row_mask:0xf bank_mask:0xf
    v_and_b32_dpp v17, v42, v5 row_newbcast:8 row_mask:0xf bank_mask:0xf
    v_and_b32_dpp v18, v42, v6 row_newbcast:8 row_mask:0xf bank_mask:0xf
    v_and_b32_dpp v19, v42, v7 row_newbcast:8 row_mask:0xf bank_mask:0xf
    buffer_load_dwordx4 v[196:199], v24, s[56:59], s73 offen nt
    s_addk_i32 s73, 0x2000
    s_cmp_eq_u32 s73, 180224
    s_cselect_b32 s73, 0, s73
    s_waitcnt vmcnt(3)
    v_mfma_f32_16x16x32_bf16 v[12:15], v[16:19], v[184:187], v[12:15]
    v_and_b32_dpp v20, v42, v4 row_newbcast:9 row_mask:0xf bank_mask:0xf
    v_and_b32_dpp v21, v42, v5 row_newbcast:9 row_mask:0xf bank_mask:0xf
    v_and_b32_dpp v22, v42, v6 row_newbcast:9 row_mask:0xf bank_mask:0xf
    v_and_b32_dpp v23, v42, v7 row_newbcast:9 row_mask:0xf bank_mask:0xf
    buffer_load_dwordx4 v[200:203], v24, s[56:59], s73 offen nt
    s_addk_i32 s73, 0x2000
    s_cmp_eq_u32 s73, 180224
    s_cselect_b32 s73, 0, s73
    s_waitcnt vmcnt(3)
    v_mfma_f32_16x16x32_bf16 v[12:15], v[20:23], v[188:191], v[12:15]
    v_and_b32_dpp v16, v42, v4 row_newbcast:10 row_mask:0xf bank_mask:0xf
    v_and_b32_dpp v17, v42, v5 row_newbcast:10 row_mask:0xf bank_mask:0xf
    v_and_b32_dpp v18, v42, v6 row_newbcast:10 row_mask:0xf bank_mask:0xf
    v_and_b32_dpp v19, v42, v7 row_newbcast:10 row_mask:0xf bank_mask:0xf
    buffer_load_dwordx4 v[204:207], v24, s[56:59], s73 offen nt
    s_addk_i32 s73, 0x2000
    s_cmp_eq_u32 s73, 180224
    s_cselect_b32 s73, 0, s73
    s_waitcnt vmcnt(3)
    v_mfma_f32_16x16x32_bf16 v[12:15], v[16:19], v[192:195], v[12:15]
    v_and_b32_dpp v20, v42, v4 row_newbcast:11 row_mask:0xf bank_mask:0xf
    v_and_b32_dpp v21, v42, v5 row_newbcast:11 row_mask:0xf bank_mask:0xf
    v_and_b32_dpp v22, v42, v6 row_newbcast:11 row_mask:0xf bank_mask:0xf
    v_and_b32_dpp v23, v42, v7 row_newbcast:11 row_mask:0xf bank_mask:0xf
    buffer_load_dwordx4 v[208:211], v24, s[56:59], s73 offen nt
    s_addk_i32 s73, 0x2000
    s_cmp_eq_u32 s73, 180224
    s_cselect_b32 s73, 0, s73
    s_waitcnt vmcnt(3)
    v_mfma_f32_16x16x32_bf16 v[12:15], v[20:23], v[196:199], v[12:15]
    v_and_b32_dpp v16, v42, v4 row_newbcast:12 row_mask:0xf bank_mask:0xf
    v_and_b32_dpp v17, v42, v5 row_newbcast:12 row_mask:0xf bank_mask:0xf
    v_and_b32_dpp v18, v42, v6 row_newbcast:12 row_mask:0xf bank_mask:0xf
    v_and_b32_dpp v19, v42, v7 row_newbcast:12 row_mask:0xf bank_mask:0xf
    buffer_load_dwordx4 v[212:215], v24, s[56:59], s73 offen nt
    s_addk_i32 s73, 0x2000
    s_cmp_eq_u32 s73, 180224
    s_cselect_b32 s73, 0, s73
    s_waitcnt vmcnt(3)
    v_mfma_f32_16x16x32_bf16 v[12:15], v[16:19], v[200:203], v[12:15]
    v_and_b32_dpp v20, v42, v4 row_newbcast:13 row_mask:0xf bank_mask:0xf
    v_and_b32_dpp v21, v42, v5 row_newbcast:13 row_mask:0xf bank_mask:0xf
    v_and_b32_dpp v22, v42, v6 row_newbcast:13 row_mask:0xf bank_mask:0xf
    v_and_b32_dpp v23, v42, v7 row_newbcast:13 row_mask:0xf bank_mask:0xf
    buffer_load_dwordx4 v[216:219], v24, s[56:59], s73 offen nt
    s_addk_i32 s73, 0x2000
    s_cmp_eq_u32 s73, 180224
    s_cselect_b32 s73, 0, s73
    s_waitcnt vmcnt(3)
    v_mfma_f32_16x16x32_bf16 v[12:15], v[20:23], v[204:207], v[12:15]
    v_and_b32_dpp v16, v42, v4 row_newbcast:14 row_mask:0xf bank_mask:0xf
    v_and_b32_dpp v17, v42, v5 row_newbcast:14 row_mask:0xf bank_mask:0xf
    v_and_b32_dpp v18, v42, v6 row_newbcast:14 row_mask:0xf bank_mask:0xf
    v_and_b32_dpp v19, v42, v7 row_newbcast:14 row_mask:0xf bank_mask:0xf
    buffer_load_dwordx4 v[220:223], v24, s[56:59], s73 offen nt
    s_addk_i32 s73, 0x2000
    s_cmp_eq_u32 s73, 180224
    s_cselect_b32 s73, 0, s73
    s_waitcnt vmcnt(3)
    v_mfma_f32_16x16x32_bf16 v[12:15], v[16:19], v[208:211], v[12:15]
    v_and_b32_dpp v20, v42, v4 row_newbcast:15 row_mask:0xf bank_mask:0xf
    v_and_b32_dpp v21, v42, v5 row_newbcast:15 row_mask:0xf bank_mask:0xf
    v_and_b32_dpp v22, v42, v6 row_newbcast:15 row_mask:0xf bank_mask:0xf
    v_and_b32_dpp v23, v42, v7 row_newbcast:15 row_mask:0xf bank_mask:0xf
    buffer_load_dwordx4 v[224:227], v24, s[56:59], s73 offen nt
    s_addk_i32 s73, 0x2000
    s_cmp_eq_u32 s73, 180224
    s_cselect_b32 s73, 0, s73
    s_waitcnt vmcnt(3)
    v_mfma_f32_16x16x32_bf16 v[12:15], v[20:23], v[212:215], v[12:15]
    v_and_b32_dpp v16, v43, v4 row_newbcast:0 row_mask:0xf bank_mask:0xf
    v_and_b32_dpp v17, v43, v5 row_newbcast:0 row_mask:0xf bank_mask:0xf
    v_and_b32_dpp v18, v43, v6 row_newbcast:0 row_mask:0xf bank_mask:0xf
    v_and_b32_dpp v19, v43, v7 row_newbcast:0 row_mask:0xf bank_mask:0xf
    buffer_load_dwordx4 v[228:231], v24, s[56:59], s73 offen nt
    s_addk_i32 s73, 0x2000
    s_cmp_eq_u32 s73, 180224
    s_cselect_b32 s73, 0, s73
    s_waitcnt vmcnt(3)
    v_mfma_f32_16x16x32_bf16 v[12:15], v[16:19], v[216:219], v[12:15]
    v_and_b32_dpp v20, v43, v4 row_newbcast:1 row_mask:0xf bank_mask:0xf
    v_and_b32_dpp v21, v43, v5 row_newbcast:1 row_mask:0xf bank_mask:0xf
    v_and_b32_dpp v22, v43, v6 row_newbcast:1 row_mask:0xf bank_mask:0xf
    v_and_b32_dpp v23, v43, v7 row_newbcast:1 row_mask:0xf bank_mask:0xf
    buffer_load_dwordx4 v[232:235], v24, s[56:59], s73 offen nt
    s_addk_i32 s73, 0x2000
    s_cmp_eq_u32 s73, 180224
    s_cselect_b32 s73, 0, s73
    s_waitcnt vmcnt(3)
    v_mfma_f32_16x16x32_bf16 v[12:15], v[20:23], v[220:223], v[12:15]
    v_and_b32_dpp v16, v43, v4 row_newbcast:2 row_mask:0xf bank_mask:0xf
    v_and_b32_dpp v17, v43, v5 row_newbcast:2 row_mask:0xf bank_mask:0xf
    v_and_b32_dpp v18, v43, v6 row_newbcast:2 row_mask:0xf bank_mask:0xf
    v_and_b32_dpp v19, v43, v7 row_newbcast:2 row_mask:0xf bank_mask:0xf
    s_cmp_lg_u32 s3, 0
    s_nop 2
    s_cbranch_scc1 L_nc_8
    s_mov_b32 s15, 0
L_mlchk_9:
    v_xor_b32 v37, s4, v37
    v_xor_b32 v39, s4, v39
    v_or_b32 v30, v37, v39
    v_cmp_ne_u32 vcc, 0, v30
    s_nop 0
    s_cmp_eq_u64 vcc, 0
    s_nop 2
    s_cbranch_scc1 L_mldone_10
    s_add_u32 s15, s15, 1
    s_cmp_gt_u32 s15, 200000
    s_cbranch_scc1 L_mldone_10
    v_and_b32 v29, 7, v0
    v_min_u32 v29, 5, v29
    v_lshlrev_b32 v29, 4, v29
    s_lshl_b32 s8, s6, 7
    s_add_u32 s8, s8, 4096
    buffer_load_dwordx4 v[36:39], v29, s[48:51], s8 offen sc1
    s_waitcnt vmcnt(0)
    s_branch L_mlchk_9
L_mldone_10:
    v_and_b32 v29, 7, v0
    v_cmp_gt_u32 vcc, 6, v29
    s_nop 1
    v_cndmask_b32 v38, 0, v38, vcc
    v_mov_b32 v31, v36
    s_nop 1
    v_max_f32_dpp v31, v31, v31 row_ror:4 row_mask:0xf bank_mask:0xf
    s_nop 1
    v_max_f32_dpp v31, v31, v31 row_ror:2 row_mask:0xf bank_mask:0xf
    s_nop 1
    v_max_f32_dpp v31, v31, v31 row_ror:1 row_mask:0xf bank_mask:0xf
    v_sub_f32 v32, v36, v31
    v_exp_f32 v32, v32
    s_nop 0
    v_mul_f32 v32, v32, v38
    s_nop 1
    v_add_f32_dpp v32, v32, v32 row_ror:4 row_mask:0xf bank_mask:0xf
    s_nop 1
    v_add_f32_dpp v32, v32, v32 row_ror:2 row_mask:0xf bank_mask:0xf
    s_nop 1
    v_add_f32_dpp v32, v32, v32 row_ror:1 row_mask:0xf bank_mask:0xf
    v_rcp_f32 v32, v32
    v_sub_f32 v33, v47, v31
    v_exp_f32 v33, v33
    s_nop 0
    v_mul_f32 v33, v33, v32
    s_nop 0
    v_readlane_b32 s92, v33, 0
    v_readlane_b32 s93, v33, 1
    v_readlane_b32 s94, v33, 2
    v_readlane_b32 s95, v33, 3
    v_readlane_b32 s96, v33, 4
    v_readlane_b32 s97, v33, 5
    v_readlane_b32 s98, v33, 6
    v_readlane_b32 s99, v33, 7
    s_nop 4
L_nc_8:
    buffer_load_dwordx4 v[236:239], v24, s[56:59], s73 offen nt
    s_addk_i32 s73, 0x2000
    s_cmp_eq_u32 s73, 180224
    s_cselect_b32 s73, 0, s73
    s_lshl_b32 s7, s3, 4
    v_add_u32 v29, s7, v1
    v_mul_u32_u24 v29, 1280, v29
    v_lshlrev_b32 v30, 4, v2
    v_add_u32 v25, v29, v30
    s_mov_b32 s7, 0
    buffer_load_dwordx4 v[48:51], v25, s[64:67], s7 offen nt
    s_mov_b32 s7, 5120
    buffer_load_dwordx4 v[52:55], v25, s[64:67], s7 offen nt
    s_mov_b32 s7, 10240
    buffer_load_dwordx4 v[56:59], v25, s[64:67], s7 offen nt
    s_mov_b32 s7, 15360
    buffer_load_dwordx4 v[60:63], v25, s[64:67], s7 offen nt
    s_waitcnt vmcnt(7)
    v_mfma_f32_16x16x32_bf16 v[12:15], v[16:19], v[224:227], v[12:15]
    v_and_b32_dpp v20, v43, v4 row_newbcast:3 row_mask:0xf bank_mask:0xf
    v_and_b32_dpp v21, v43, v5 row_newbcast:3 row_mask:0xf bank_mask:0xf
    v_and_b32_dpp v22, v43, v6 row_newbcast:3 row_mask:0xf bank_mask:0xf
    v_and_b32_dpp v23, v43, v7 row_newbcast:3 row_mask:0xf bank_mask:0xf
    s_waitcnt vmcnt(6)
    s_nop 0
    v_mfma_f32_16x16x32_bf16 v[12:15], v[20:23], v[228:231], v[12:15]
    v_and_b32_dpp v16, v43, v4 row_newbcast:4 row_mask:0xf bank_mask:0xf
    v_and_b32_dpp v17, v43, v5 row_newbcast:4 row_mask:0xf bank_mask:0xf
    v_and_b32_dpp v18, v43, v6 row_newbcast:4 row_mask:0xf bank_mask:0xf
    v_and_b32_dpp v19, v43, v7 row_newbcast:4 row_mask:0xf bank_mask:0xf
    s_waitcnt vmcnt(5)
    s_nop 0
    v_mfma_f32_16x16x32_bf16 v[12:15], v[16:19], v[232:235], v[12:15]
    v_and_b32_dpp v20, v43, v4 row_newbcast:5 row_mask:0xf bank_mask:0xf
    v_and_b32_dpp v21, v43, v5 row_newbcast:5 row_mask:0xf bank_mask:0xf
    v_and_b32_dpp v22, v43, v6 row_newbcast:5 row_mask:0xf bank_mask:0xf
    v_and_b32_dpp v23, v43, v7 row_newbcast:5 row_mask:0xf bank_mask:0xf
    s_waitcnt vmcnt(4)
    s_nop 0
    v_mfma_f32_16x16x32_bf16 v[12:15], v[20:23], v[236:239], v[12:15]
    s_mov_b32 exec_lo, 0xffffffff
    s_mov_b32 exec_hi, 0x0
    s_nop 5
    ds_write_b128 v27, v[12:15] offset:4096
    s_mov_b64 exec, -1
    s_waitcnt lgkmcnt(0)
    s_barrier
    s_cmp_lg_u32 s3, 0
    s_cbranch_scc1 L_nc_11
    s_setprio 2
    v_lshlrev_b32 v29, 3, v0
    ds_read_b64 v[64:65], v29 offset:4096
    ds_read_b64 v[66:67], v29 offset:4608
    ds_read_b64 v[68:69], v29 offset:5120
    ds_read_b64 v[70:71], v29 offset:5632
    ds_read_b64 v[72:73], v29 offset:6144
    ds_read_b64 v[74:75], v29 offset:6656
    ds_read_b64 v[76:77], v29 offset:7168
    ds_read_b64 v[78:79], v29 offset:7680
    s_mul_i32 s8, s6, 6
    s_add_u32 s9, s8, s5
    s_lshl_b32 s9, s9, 10
    s_add_u32 s9, s9, 204800
    v_mov_b32 v37, s4
    v_mov_b32 v39, s4
    s_waitcnt lgkmcnt(0)
    v_mul_f32 v36, s92, v64
    v_mul_f32 v38, s92, v65
    v_mul_f32 v30, s93, v66
    v_mul_f32 v31, s93, v67
    v_fmac_f32 v36, s94, v68
    v_fmac_f32 v38, s94, v69
    v_fmac_f32 v30, s95, v70
    v_fmac_f32 v31, s95, v71
    v_fmac_f32 v36, s96, v72
    v_fmac_f32 v38, s96, v73
    v_fmac_f32 v30, s97, v74
    v_fmac_f32 v31, s97, v75
    v_fmac_f32 v36, s98, v76
    v_fmac_f32 v38, s98, v77
    v_fmac_f32 v30, s99, v78
    v_fmac_f32 v31, s99, v79
    v_add_f32 v36, v36, v30
    v_add_f32 v38, v38, v31
    s_add_u32 s8, s9, 2940928
    buffer_store_dwordx4 v[36:39], v28, s[48:51], s8 offen
    buffer_store_dwordx4 v[36:39], v28, s[48:51], s9 offen sc1
    s_setprio 0
    s_nop 0
L_nc_11:
    v_lshrrev_b32 v29, 3, v0
    v_lshlrev_b32 v29, 10, v29
    v_and_b32 v30, 7, v0
    v_lshlrev_b32 v30, 4, v30
    s_lshl_b32 s8, s3, 7
    v_add3_u32 v29, v29, v30, s8
    s_mul_i32 s10, s6, 6144
    s_add_u32 s8, s10, 204800
    v_mov_b32 v96, 0
    v_mov_b32 v98, 0
    s_mov_b32 exec_lo, 0xffffffff
    s_mov_b32 exec_hi, 0xffff
    s_mov_b32 s15, 0
L_pq_12:
    s_cmp_lt_u32 s15, 64
    s_mov_b32 s8, 204800
    s_cselect_b32 s8, 3145728, s8
    s_add_u32 s8, s8, s10
    buffer_load_dwordx4 v[100:103], v29, s[48:51], s8 offen sc1
    s_waitcnt vmcnt(0)
    v_xor_b32 v101, s4, v101
    v_xor_b32 v103, s4, v103
    v_or_b32 v31, v101, v103
    v_cmp_ne_u32 vcc, 0, v31
    s_nop 0
    s_cmp_eq_u64 vcc, 0
    s_cbranch_scc1 L_pqd_13
    s_add_u32 s15, s15, 1
    s_cmp_le_u32 s15, 200000
    s_cbranch_scc1 L_pq_12
L_pqd_13:
    v_mov_b32 v96, v100
    v_mov_b32 v98, v102
    s_mov_b64 exec, -1
    s_nop 0
    v_add_f32_dpp v96, v96, v96 row_ror:8 row_mask:0xf bank_mask:0xf
    v_add_f32_dpp v98, v98, v98 row_ror:8 row_mask:0xf bank_mask:0xf
    v_mov_b32 v31, v96
    v_mov_b32 v32, v98
    s_nop 0
    v_permlane16_swap_b32 v96, v31
    v_permlane16_swap_b32 v98, v32
    v_add_f32 v96, v96, v31
    v_add_f32 v98, v98, v32
    v_mov_b32 v31, v96
    v_mov_b32 v32, v98
    s_nop 0
    v_permlane32_swap_b32 v96, v31
    v_permlane32_swap_b32 v98, v32
    v_add_f32 v96, v96, v31
    v_add_f32 v98, v98, v32
    v_cvt_pk_bf16_f32 v96, v96, v96
    v_cvt_pk_bf16_f32 v98, v98, v98
    s_mov_b32 s8, 0xffff0000
    s_mov_b32 s9, 0xffff0000
    v_cndmask_b32 v96, v96, v98, s[8:9]
    s_nop 1
    v_mov_b32_dpp v96, v96 row_shl:1 row_mask:0xc bank_mask:0xf
    s_nop 1
    v_and_b32_dpp v16, v96, v4 row_newbcast:0 row_mask:0xf bank_mask:0xf
    v_and_b32_dpp v17, v96, v5 row_newbcast:0 row_mask:0xf bank_mask:0xf
    v_and_b32_dpp v18, v96, v6 row_newbcast:0 row_mask:0xf bank_mask:0xf
    v_and_b32_dpp v19, v96, v7 row_newbcast:0 row_mask:0xf bank_mask:0xf
    s_nop 1
    v_mfma_f32_16x16x32_bf16 v[12:15], v[16:19], v[48:51], 0
    v_and_b32_dpp v20, v96, v4 row_newbcast:2 row_mask:0xf bank_mask:0xf
    v_and_b32_dpp v21, v96, v5 row_newbcast:2 row_mask:0xf bank_mask:0xf
    v_and_b32_dpp v22, v96, v6 row_newbcast:2 row_mask:0xf bank_mask:0xf
    v_and_b32_dpp v23, v96, v7 row_newbcast:2 row_mask:0xf bank_mask:0xf
    s_nop 1
    v_mfma_f32_16x16x32_bf16 v[12:15], v[20:23], v[52:55], v[12:15]
    v_and_b32_dpp v16, v96, v4 row_newbcast:4 row_mask:0xf bank_mask:0xf
    v_and_b32_dpp v17, v96, v5 row_newbcast:4 row_mask:0xf bank_mask:0xf
    v_and_b32_dpp v18, v96, v6 row_newbcast:4 row_mask:0xf bank_mask:0xf
    v_and_b32_dpp v19, v96, v7 row_newbcast:4 row_mask:0xf bank_mask:0xf
    s_nop 1
    v_mfma_f32_16x16x32_bf16 v[12:15], v[16:19], v[56:59], v[12:15]
    v_and_b32_dpp v20, v96, v4 row_newbcast:6 row_mask:0xf bank_mask:0xf
    v_and_b32_dpp v21, v96, v5 row_newbcast:6 row_mask:0xf bank_mask:0xf
    v_and_b32_dpp v22, v96, v6 row_newbcast:6 row_mask:0xf bank_mask:0xf
    v_and_b32_dpp v23, v96, v7 row_newbcast:6 row_mask:0xf bank_mask:0xf
    s_nop 1
    v_mfma_f32_16x16x32_bf16 v[12:15], v[20:23], v[60:63], v[12:15]
    s_mov_b32 exec_lo, 0xffffffff
    s_mov_b32 exec_hi, 0x0
    s_nop 5
    ds_write_b128 v27, v[12:15] offset:8192
    s_mov_b64 exec, -1
    s_waitcnt lgkmcnt(0)
    s_barrier
    s_cmp_lg_u32 s3, 0
    s_cbranch_scc1 L_nc_14
    v_lshlrev_b32 v29, 3, v0
    ds_read_b64 v[64:65], v29 offset:8192
    ds_read_b64 v[66:67], v29 offset:8704
    ds_read_b64 v[68:69], v29 offset:9216
    ds_read_b64 v[70:71], v29 offset:9728
    ds_read_b64 v[72:73], v29 offset:10240
    ds_read_b64 v[74:75], v29 offset:10752
    ds_read_b64 v[76:77], v29 offset:11264
    ds_read_b64 v[78:79], v29 offset:11776
    s_lshl_b32 s8, s5, 5
    s_add_u32 s8, s8, s6
    s_lshl_b32 s8, s8, 10
    s_add_u32 s8, s8, 401408
    v_mov_b32 v37, s4
    v_mov_b32 v39, s4
    s_waitcnt lgkmcnt(0)
    v_add_f32 v64, v64, v66
    v_add_f32 v65, v65, v67
    v_add_f32 v68, v68, v70
    v_add_f32 v69, v69, v71
    v_add_f32 v72, v72, v74
    v_add_f32 v73, v73, v75
    v_add_f32 v76, v76, v78
    v_add_f32 v77, v77, v79
    v_add_f32 v64, v64, v68
    v_add_f32 v65, v65, v69
    v_add_f32 v72, v72, v76
    v_add_f32 v73, v73, v77
    v_add_f32 v36, v64, v72
    v_add_f32 v38, v65, v73
    buffer_store_dwordx4 v[36:39], v28, s[48:51], s8 offen sc1
    s_nop 1
L_nc_14:
    s_endpgm
L_B5_0:
    s_and_b32 s72, s6, 15
    s_lshl_b32 s72, s72, 13
    s_mov_b32 s73, s72
    buffer_load_dwordx4 v[64:67], v24, s[52:55], s72 offen nt
    s_addk_i32 s72, 0x2000
    s_cmp_eq_u32 s72, 180224
    s_cselect_b32 s72, 0, s72
    buffer_load_dwordx4 v[68:71], v24, s[52:55], s72 offen nt
    s_addk_i32 s72, 0x2000
    s_cmp_eq_u32 s72, 180224
    s_cselect_b32 s72, 0, s72
    v_lshrrev_b32 v3, 1, v2
    v_and_b32 v29, 1, v2
    v_lshlrev_b32 v29, 4, v29
    v_mov_b32 v30, 0xffff
    v_lshlrev_b32 v29, v29, v30
    v_cmp_eq_u32 vcc, 0, v3
    s_nop 1
    v_cndmask_b32 v4, 0, v29, vcc
    v_cmp_eq_u32 vcc, 1, v3
    s_nop 1
    v_cndmask_b32 v5, 0, v29, vcc
    v_cmp_eq_u32 vcc, 2, v3
    s_nop 1
    v_cndmask_b32 v6, 0, v29, vcc
    v_cmp_eq_u32 vcc, 3, v3
    s_nop 1
    v_cndmask_b32 v7, 0, v29, vcc
    s_lshl_b32 s9, s3, 9
    v_lshlrev_b32 v27, 5, v2
    v_lshlrev_b32 v30, 4, v1
    v_add3_u32 v27, v27, v30, s9
    s_waitcnt lgkmcnt(0)
    s_add_u32 s4, s4, 0x9e3779b1
    s_waitcnt vmcnt(6)
    v_lshl_or_b32 v31, v31, 16, v31
    v_and_b32 v16, v31, v4
    v_and_b32 v17, v31, v5
    v_and_b32 v18, v31, v6
    v_and_b32 v19, v31, v7
    s_nop 1
    v_mfma_f32_16x16x32_bf16 v[12:15], v[16:19], v[236:239], 0
    s_waitcnt vmcnt(5)
    v_lshl_or_b32 v32, v32, 16, v32
    v_and_b32 v20, v32, v4
    v_and_b32 v21, v32, v5
    v_and_b32 v22, v32, v6
    v_and_b32 v23, v32, v7
    s_nop 1
    v_mfma_f32_16x16x32_bf16 v[12:15], v[20:23], v[240:243], v[12:15]
    s_waitcnt vmcnt(4)
    v_lshl_or_b32 v33, v33, 16, v33
    v_and_b32 v16, v33, v4
    v_and_b32 v17, v33, v5
    v_and_b32 v18, v33, v6
    v_and_b32 v19, v33, v7
    s_nop 1
    v_mfma_f32_16x16x32_bf16 v[12:15], v[16:19], v[244:247], v[12:15]
    s_waitcnt vmcnt(3)
    v_lshl_or_b32 v34, v34, 16, v34
    v_and_b32 v20, v34, v4
    v_and_b32 v21, v34, v5
    v_and_b32 v22, v34, v6
    v_and_b32 v23, v34, v7
    s_nop 1
    v_mfma_f32_16x16x32_bf16 v[12:15], v[20:23], v[248:251], v[12:15]
    s_waitcnt vmcnt(2)
    v_lshl_or_b32 v35, v35, 16, v35
    v_and_b32 v16, v35, v4
    v_and_b32 v17, v35, v5
    v_and_b32 v18, v35, v6
    v_and_b32 v19, v35, v7
    s_nop 1
    v_mfma_f32_16x16x32_bf16 v[12:15], v[16:19], v[252:255], v[12:15]
    s_mov_b32 exec_lo, 0xffffffff
    s_mov_b32 exec_hi, 0x0
    s_nop 5
    ds_write_b128 v27, v[12:15] offset:0
    s_mov_b64 exec, -1
    s_waitcnt lgkmcnt(0)
    s_barrier
    s_and_b32 s7, s3, 3
    s_cmp_lg_u32 s7, 3
    s_cbranch_scc1 L_s1p_15
    s_setprio 2
    s_and_b32 s7, s3, 4
    s_lshl_b32 s7, s7, 9
    v_lshlrev_b32 v29, 3, v0
    v_add_u32 v29, s7, v29
    ds_read_b64 v[208:209], v29 offset:0
    ds_read_b64 v[210:211], v29 offset:512
    ds_read_b64 v[212:213], v29 offset:1024
    ds_read_b64 v[214:215], v29 offset:1536
    s_lshl_b32 s8, s6, 3
    s_add_u32 s8, s8, s5
    s_lshl_b32 s8, s8, 10
    s_cmp_eq_u32 s3, 3
    s_mov_b32 s9, 2359296
    s_cselect_b32 s9, 2621440, s9
    s_add_u32 s9, s9, s8
    v_mov_b32 v37, s4
    v_mov_b32 v39, s4
    s_waitcnt lgkmcnt(0)
    v_add_f32 v208, v208, v210
    v_add_f32 v209, v209, v211
    v_add_f32 v212, v212, v214
    v_add_f32 v213, v213, v215
    v_add_f32 v36, v208, v212
    v_add_f32 v38, v209, v213
    s_cmp_eq_u32 s3, 3
    s_mov_b32 s7, 3604480
    s_cselect_b32 s7, 2883584, s7
    s_add_u32 s8, s8, s7
    buffer_store_dwordx4 v[36:39], v28, s[48:51], s8 offen
    buffer_store_dwordx4 v[36:39], v28, s[48:51], s9 offen sc1
    s_setprio 0
    s_nop 0
L_s1p_15:
    buffer_load_dwordx4 v[72:75], v24, s[52:55], s72 offen nt
    s_addk_i32 s72, 0x2000
    s_cmp_eq_u32 s72, 180224
    s_cselect_b32 s72, 0, s72
    s_waitcnt vmcnt(2)
    buffer_load_dwordx4 v[76:79], v24, s[52:55], s72 offen nt
    s_addk_i32 s72, 0x2000
    s_cmp_eq_u32 s72, 180224
    s_cselect_b32 s72, 0, s72
    s_waitcnt vmcnt(2)
    buffer_load_dwordx4 v[80:83], v24, s[52:55], s72 offen nt
    s_addk_i32 s72, 0x2000
    s_cmp_eq_u32 s72, 180224
    s_cselect_b32 s72, 0, s72
    s_waitcnt vmcnt(2)
    buffer_load_dwordx4 v[84:87], v24, s[52:55], s72 offen nt
    s_addk_i32 s72, 0x2000
    s_cmp_eq_u32 s72, 180224
    s_cselect_b32 s72, 0, s72
    s_waitcnt vmcnt(2)
    buffer_load_dwordx4 v[88:91], v24, s[52:55], s72 offen nt
    s_addk_i32 s72, 0x2000
    s_cmp_eq_u32 s72, 180224
    s_cselect_b32 s72, 0, s72
    s_waitcnt vmcnt(2)
    buffer_load_dwordx4 v[92:95], v24, s[52:55], s72 offen nt
    s_addk_i32 s72, 0x2000
    s_cmp_eq_u32 s72, 180224
    s_cselect_b32 s72, 0, s72
    s_waitcnt vmcnt(2)
    buffer_load_dwordx4 v[96:99], v24, s[52:55], s72 offen nt
    s_addk_i32 s72, 0x2000
    s_cmp_eq_u32 s72, 180224
    s_cselect_b32 s72, 0, s72
    s_cmp_lg_u32 s3, 0
    s_cbranch_scc1 L_nc_16
    s_mov_b32 s15, 0
    s_cmp_lt_u32 s15, 64
    s_mov_b32 s9, 2359296
    s_cselect_b32 s9, 3604480, s9
    s_lshl_b32 s8, s6, 13
    s_add_u32 s8, s8, s9
    buffer_load_dwordx4 v[208:211], v28, s[48:51], s8 offen sc1
    s_addk_i32 s8, 0x400
    buffer_load_dwordx4 v[212:215], v28, s[48:51], s8 offen sc1
    s_addk_i32 s8, 0x400
    buffer_load_dwordx4 v[216:219], v28, s[48:51], s8 offen sc1
    s_addk_i32 s8, 0x400
    buffer_load_dwordx4 v[220:223], v28, s[48:51], s8 offen sc1
    s_addk_i32 s8, 0x400
    buffer_load_dwordx4 v[224:227], v28, s[48:51], s8 offen sc1
    s_addk_i32 s8, 0x400
    buffer_load_dwordx4 v[228:231], v28, s[48:51], s8 offen sc1
    s_addk_i32 s8, 0x400
    buffer_load_dwordx4 v[232:235], v28, s[48:51], s8 offen sc1
    s_addk_i32 s8, 0x400
    buffer_load_dwordx4 v[236:239], v28, s[48:51], s8 offen sc1
L_nc_16:
    s_waitcnt vmcnt(2)
    buffer_load_dwordx4 v[100:103], v24, s[52:55], s72 offen nt
    s_addk_i32 s72, 0x2000
    s_cmp_eq_u32 s72, 180224
    s_cselect_b32 s72, 0, s72
    s_waitcnt vmcnt(2)
    buffer_load_dwordx4 v[104:107], v24, s[52:55], s72 offen nt
    s_addk_i32 s72, 0x2000
    s_cmp_eq_u32 s72, 180224
    s_cselect_b32 s72, 0, s72
    s_waitcnt vmcnt(2)
    buffer_load_dwordx4 v[108:111], v24, s[52:55], s72 offen nt
    s_addk_i32 s72, 0x2000
    s_cmp_eq_u32 s72, 180224
    s_cselect_b32 s72, 0, s72
    s_waitcnt vmcnt(2)
    buffer_load_dwordx4 v[112:115], v24, s[52:55], s72 offen nt
    s_addk_i32 s72, 0x2000
    s_cmp_eq_u32 s72, 180224
    s_cselect_b32 s72, 0, s72
    s_waitcnt vmcnt(2)
    buffer_load_dwordx4 v[116:119], v24, s[52:55], s72 offen nt
    s_addk_i32 s72, 0x2000
    s_cmp_eq_u32 s72, 180224
    s_cselect_b32 s72, 0, s72
    s_waitcnt vmcnt(2)
    buffer_load_dwordx4 v[120:123], v24, s[52:55], s72 offen nt
    s_addk_i32 s72, 0x2000
    s_cmp_eq_u32 s72, 180224
    s_cselect_b32 s72, 0, s72
    s_waitcnt vmcnt(2)
    buffer_load_dwordx4 v[124:127], v24, s[52:55], s72 offen nt
    s_addk_i32 s72, 0x2000
    s_cmp_eq_u32 s72, 180224
    s_cselect_b32 s72, 0, s72
    s_waitcnt vmcnt(2)
    buffer_load_dwordx4 v[128:131], v24, s[52:55], s72 offen nt
    s_addk_i32 s72, 0x2000
    s_cmp_eq_u32 s72, 180224
    s_cselect_b32 s72, 0, s72
    s_waitcnt vmcnt(2)
    buffer_load_dwordx4 v[132:135], v24, s[52:55], s72 offen nt
    s_addk_i32 s72, 0x2000
    s_cmp_eq_u32 s72, 180224
    s_cselect_b32 s72, 0, s72
    s_waitcnt vmcnt(2)
    buffer_load_dwordx4 v[136:139], v24, s[52:55], s72 offen nt
    s_addk_i32 s72, 0x2000
    s_cmp_eq_u32 s72, 180224
    s_cselect_b32 s72, 0, s72
    s_waitcnt vmcnt(2)
    buffer_load_dwordx4 v[140:143], v24, s[52:55], s72 offen nt
    s_addk_i32 s72, 0x2000
    s_cmp_eq_u32 s72, 180224
    s_cselect_b32 s72, 0, s72
    s_waitcnt vmcnt(2)
    buffer_load_dwordx4 v[144:147], v24, s[52:55], s72 offen nt
    s_addk_i32 s72, 0x2000
    s_cmp_eq_u32 s72, 180224
    s_cselect_b32 s72, 0, s72
    s_waitcnt vmcnt(2)
    buffer_load_dwordx4 v[148:151], v24, s[52:55], s72 offen nt
    s_addk_i32 s72, 0x2000
    s_cmp_eq_u32 s72, 180224
    s_cselect_b32 s72, 0, s72
    s_waitcnt vmcnt(2)
    buffer_load_dwordx4 v[152:155], v24, s[56:59], s73 offen nt
    s_addk_i32 s73, 0x2000
    s_cmp_eq_u32 s73, 180224
    s_cselect_b32 s73, 0, s73
    s_waitcnt vmcnt(2)
    buffer_load_dwordx4 v[156:159], v24, s[56:59], s73 offen nt
    s_addk_i32 s73, 0x2000
    s_cmp_eq_u32 s73, 180224
    s_cselect_b32 s73, 0, s73
    s_cmp_lg_u32 s3, 0
    s_cbranch_scc1 L_nc_17
    s_setprio 2
L_qchk_18:
    v_xor_b32 v209, s4, v209
    v_xor_b32 v211, s4, v211
    v_or_b32 v29, v209, v211
    v_xor_b32 v213, s4, v213
    v_xor_b32 v215, s4, v215
    v_or3_b32 v29, v29, v213, v215
    v_xor_b32 v217, s4, v217
    v_xor_b32 v219, s4, v219
    v_or3_b32 v29, v29, v217, v219
    v_xor_b32 v221, s4, v221
    v_xor_b32 v223, s4, v223
    v_or3_b32 v29, v29, v221, v223
    v_xor_b32 v225, s4, v225
    v_xor_b32 v227, s4, v227
    v_or3_b32 v29, v29, v225, v227
    v_xor_b32 v229, s4, v229
    v_xor_b32 v231, s4, v231
    v_or3_b32 v29, v29, v229, v231
    v_xor_b32 v233, s4, v233
    v_xor_b32 v235, s4, v235
    v_or3_b32 v29, v29, v233, v235
    v_xor_b32 v237, s4, v237
    v_xor_b32 v239, s4, v239
    v_or3_b32 v29, v29, v237, v239
    v_cmp_ne_u32 vcc, 0, v29
    s_nop 0
    s_cmp_eq_u64 vcc, 0
    s_nop 2
    s_cbranch_scc1 L_qdone_19
    s_add_u32 s15, s15, 1
    s_cmp_gt_u32 s15, 200000
    s_cbranch_scc1 L_qdone_19
    s_cmp_lt_u32 s15, 64
    s_mov_b32 s9, 2359296
    s_cselect_b32 s9, 3604480, s9
    s_lshl_b32 s8, s6, 13
    s_add_u32 s8, s8, s9
    buffer_load_dwordx4 v[208:211], v28, s[48:51], s8 offen sc1
    s_addk_i32 s8, 0x400
    buffer_load_dwordx4 v[212:215], v28, s[48:51], s8 offen sc1
    s_addk_i32 s8, 0x400
    buffer_load_dwordx4 v[216:219], v28, s[48:51], s8 offen sc1
    s_addk_i32 s8, 0x400
    buffer_load_dwordx4 v[220:223], v28, s[48:51], s8 offen sc1
    s_addk_i32 s8, 0x400
    buffer_load_dwordx4 v[224:227], v28, s[48:51], s8 offen sc1
    s_addk_i32 s8, 0x400
    buffer_load_dwordx4 v[228:231], v28, s[48:51], s8 offen sc1
    s_addk_i32 s8, 0x400
    buffer_load_dwordx4 v[232:235], v28, s[48:51], s8 offen sc1
    s_addk_i32 s8, 0x400
    buffer_load_dwordx4 v[236:239], v28, s[48:51], s8 offen sc1
    s_waitcnt vmcnt(0)
    s_branch L_qchk_18
L_qdone_19:
    v_add_f32 v208, v208, v212
    v_add_f32 v210, v210, v214
    v_add_f32 v216, v216, v220
    v_add_f32 v218, v218, v222
    v_add_f32 v224, v224, v228
    v_add_f32 v226, v226, v230
    v_add_f32 v232, v232, v236
    v_add_f32 v234, v234, v238
    v_add_f32 v208, v208, v216
    v_add_f32 v210, v210, v218
    v_add_f32 v224, v224, v232
    v_add_f32 v226, v226, v234
    v_add_f32 v208, v208, v224
    v_add_f32 v210, v210, v226
    v_cvt_pk_bf16_f32 v208, v208, v210
    v_lshlrev_b32 v29, 2, v0
    v_add_u32 v29, 12288, v29
    ds_write_b32 v29, v208
    s_waitcnt lgkmcnt(0)
    s_setprio 0
L_nc_17:
    s_barrier
    v_lshlrev_b32 v29, 4, v2
    ds_read_b128 v[8:11], v29 offset:12288
    s_waitcnt lgkmcnt(0)
    buffer_load_dwordx4 v[160:163], v24, s[56:59], s73 offen nt
    s_addk_i32 s73, 0x2000
    s_cmp_eq_u32 s73, 180224
    s_cselect_b32 s73, 0, s73
    v_dot2_f32_bf16 v64, v64, v8, 0
    v_dot2_f32_bf16 v68, v68, v8, 0
    v_dot2_f32_bf16 v72, v72, v8, 0
    v_dot2_f32_bf16 v76, v76, v8, 0
    v_dot2_f32_bf16 v64, v65, v9, v64
    v_dot2_f32_bf16 v68, v69, v9, v68
    v_dot2_f32_bf16 v72, v73, v9, v72
    v_dot2_f32_bf16 v76, v77, v9, v76
    v_dot2_f32_bf16 v64, v66, v10, v64
    v_dot2_f32_bf16 v68, v70, v10, v68
    v_dot2_f32_bf16 v72, v74, v10, v72
    v_dot2_f32_bf16 v76, v78, v10, v76
    v_dot2_f32_bf16 v64, v67, v11, v64
    v_dot2_f32_bf16 v68, v71, v11, v68
    v_dot2_f32_bf16 v72, v75, v11, v72
    v_dot2_f32_bf16 v76, v79, v11, v76
    v_dot2_f32_bf16 v80, v80, v8, 0
    v_dot2_f32_bf16 v84, v84, v8, 0
    v_dot2_f32_bf16 v88, v88, v8, 0
    v_dot2_f32_bf16 v92, v92, v8, 0
    v_dot2_f32_bf16 v80, v81, v9, v80
    v_dot2_f32_bf16 v84, v85, v9, v84
    v_dot2_f32_bf16 v88, v89, v9, v88
    v_dot2_f32_bf16 v92, v93, v9, v92
    v_dot2_f32_bf16 v80, v82, v10, v80
    v_dot2_f32_bf16 v84, v86, v10, v84
    v_dot2_f32_bf16 v88, v90, v10, v88
    v_dot2_f32_bf16 v92, v94, v10, v92
    v_dot2_f32_bf16 v80, v83, v11, v80
    v_dot2_f32_bf16 v84, v87, v11, v84
    v_dot2_f32_bf16 v88, v91, v11, v88
    v_dot2_f32_bf16 v92, v95, v11, v92
    v_dot2_f32_bf16 v96, v96, v8, 0
    v_dot2_f32_bf16 v100, v100, v8, 0
    v_dot2_f32_bf16 v104, v104, v8, 0
    v_dot2_f32_bf16 v108, v108, v8, 0
    v_dot2_f32_bf16 v96, v97, v9, v96
    v_dot2_f32_bf16 v100, v101, v9, v100
    v_dot2_f32_bf16 v104, v105, v9, v104
    v_dot2_f32_bf16 v108, v109, v9, v108
    v_dot2_f32_bf16 v96, v98, v10, v96
    v_dot2_f32_bf16 v100, v102, v10, v100
    v_dot2_f32_bf16 v104, v106, v10, v104
    v_dot2_f32_bf16 v108, v110, v10, v108
    v_dot2_f32_bf16 v96, v99, v11, v96
    v_dot2_f32_bf16 v100, v103, v11, v100
    v_dot2_f32_bf16 v104, v107, v11, v104
    v_dot2_f32_bf16 v108, v111, v11, v108
    buffer_load_dwordx4 v[164:167], v24, s[56:59], s73 offen nt
    s_addk_i32 s73, 0x2000
    s_cmp_eq_u32 s73, 180224
    s_cselect_b32 s73, 0, s73
    v_dot2_f32_bf16 v112, v112, v8, 0
    v_dot2_f32_bf16 v116, v116, v8, 0
    v_dot2_f32_bf16 v120, v120, v8, 0
    v_dot2_f32_bf16 v124, v124, v8, 0
    v_dot2_f32_bf16 v112, v113, v9, v112
    v_dot2_f32_bf16 v116, v117, v9, v116
    v_dot2_f32_bf16 v120, v121, v9, v120
    v_dot2_f32_bf16 v124, v125, v9, v124
    v_dot2_f32_bf16 v112, v114, v10, v112
    v_dot2_f32_bf16 v116, v118, v10, v116
    v_dot2_f32_bf16 v120, v122, v10, v120
    v_dot2_f32_bf16 v124, v126, v10, v124
    v_dot2_f32_bf16 v112, v115, v11, v112
    v_dot2_f32_bf16 v116, v119, v11, v116
    v_dot2_f32_bf16 v120, v123, v11, v120
    v_dot2_f32_bf16 v124, v127, v11, v124
    v_dot2_f32_bf16 v128, v128, v8, 0
    v_dot2_f32_bf16 v132, v132, v8, 0
    v_dot2_f32_bf16 v136, v136, v8, 0
    v_dot2_f32_bf16 v140, v140, v8, 0
    v_dot2_f32_bf16 v128, v129, v9, v128
    v_dot2_f32_bf16 v132, v133, v9, v132
    v_dot2_f32_bf16 v136, v137, v9, v136
    v_dot2_f32_bf16 v140, v141, v9, v140
    v_dot2_f32_bf16 v128, v130, v10, v128
    v_dot2_f32_bf16 v132, v134, v10, v132
    v_dot2_f32_bf16 v136, v138, v10, v136
    v_dot2_f32_bf16 v140, v142, v10, v140
    v_dot2_f32_bf16 v128, v131, v11, v128
    v_dot2_f32_bf16 v132, v135, v11, v132
    v_dot2_f32_bf16 v136, v139, v11, v136
    v_dot2_f32_bf16 v140, v143, v11, v140
    s_waitcnt vmcnt(4)
    v_dot2_f32_bf16 v144, v144, v8, 0
    v_dot2_f32_bf16 v148, v148, v8, 0
    v_dot2_f32_bf16 v144, v145, v9, v144
    v_dot2_f32_bf16 v148, v149, v9, v148
    v_dot2_f32_bf16 v144, v146, v10, v144
    v_dot2_f32_bf16 v148, v150, v10, v148
    v_dot2_f32_bf16 v144, v147, v11, v144
    v_dot2_f32_bf16 v148, v151, v11, v148
    v_add_f32_dpp v64, v64, v64 row_ror:8 row_mask:0xf bank_mask:0x3
    v_add_f32_dpp v68, v68, v68 row_ror:8 row_mask:0xf bank_mask:0x3
    v_add_f32_dpp v72, v72, v72 row_ror:8 row_mask:0xf bank_mask:0x3
    v_add_f32_dpp v76, v76, v76 row_ror:8 row_mask:0xf bank_mask:0x3
    v_add_f32_dpp v80, v80, v80 row_ror:8 row_mask:0xf bank_mask:0x3
    v_add_f32_dpp v84, v84, v84 row_ror:8 row_mask:0xf bank_mask:0x3
    v_add_f32_dpp v88, v88, v88 row_ror:8 row_mask:0xf bank_mask:0x3
    v_add_f32_dpp v92, v92, v92 row_ror:8 row_mask:0xf bank_mask:0x3
    v_add_f32_dpp v64, v96, v96 row_ror:8 row_mask:0xf bank_mask:0xc
    v_add_f32_dpp v68, v100, v100 row_ror:8 row_mask:0xf bank_mask:0xc
    v_add_f32_dpp v72, v104, v104 row_ror:8 row_mask:0xf bank_mask:0xc
    v_add_f32_dpp v76, v108, v108 row_ror:8 row_mask:0xf bank_mask:0xc
    v_add_f32_dpp v80, v112, v112 row_ror:8 row_mask:0xf bank_mask:0xc
    v_add_f32_dpp v84, v116, v116 row_ror:8 row_mask:0xf bank_mask:0xc
    v_add_f32_dpp v88, v120, v120 row_ror:8 row_mask:0xf bank_mask:0xc
    v_add_f32_dpp v92, v124, v124 row_ror:8 row_mask:0xf bank_mask:0xc
    v_add_f32_dpp v64, v64, v64 row_half_mirror row_mask:0xf bank_mask:0x5
    v_add_f32_dpp v68, v68, v68 row_half_mirror row_mask:0xf bank_mask:0x5
    v_add_f32_dpp v72, v72, v72 row_half_mirror row_mask:0xf bank_mask:0x5
    v_add_f32_dpp v76, v76, v76 row_half_mirror row_mask:0xf bank_mask:0x5
    v_add_f32_dpp v64, v80, v80 row_half_mirror row_mask:0xf bank_mask:0xa
    v_add_f32_dpp v68, v84, v84 row_half_mirror row_mask:0xf bank_mask:0xa
    v_add_f32_dpp v72, v88, v88 row_half_mirror row_mask:0xf bank_mask:0xa
    v_add_f32_dpp v76, v92, v92 row_half_mirror row_mask:0xf bank_mask:0xa
    v_add_f32_dpp v64, v64, v64 quad_perm:[2,3,0,1] row_mask:0xf bank_mask:0xf
    v_add_f32_dpp v68, v68, v68 quad_perm:[2,3,0,1] row_mask:0xf bank_mask:0xf
    v_add_f32_dpp v72, v72, v72 quad_perm:[2,3,0,1] row_mask:0xf bank_mask:0xf
    v_add_f32_dpp v76, v76, v76 quad_perm:[2,3,0,1] row_mask:0xf bank_mask:0xf
    s_mov_b32 s8, 0xcccccccc
    s_mov_b32 s9, 0xcccccccc
    s_mov_b32 s10, 0xaaaaaaaa
    s_mov_b32 s11, 0xaaaaaaaa
    v_cndmask_b32 v64, v64, v72, s[8:9]
    v_cndmask_b32 v68, v68, v76, s[8:9]
    s_nop 0
    v_add_f32_dpp v64, v64, v64 quad_perm:[1,0,3,2] row_mask:0xf bank_mask:0xf
    v_add_f32_dpp v68, v68, v68 quad_perm:[1,0,3,2] row_mask:0xf bank_mask:0xf
    v_cndmask_b32 v40, v64, v68, s[10:11]
    buffer_load_dwordx4 v[168:171], v24, s[56:59], s73 offen nt
    s_addk_i32 s73, 0x2000
    s_cmp_eq_u32 s73, 180224
    s_cselect_b32 s73, 0, s73
    v_add_f32_dpp v128, v128, v128 row_ror:8 row_mask:0xf bank_mask:0x3
    v_add_f32_dpp v132, v132, v132 row_ror:8 row_mask:0xf bank_mask:0x3
    v_add_f32_dpp v136, v136, v136 row_ror:8 row_mask:0xf bank_mask:0x3
    v_add_f32_dpp v140, v140, v140 row_ror:8 row_mask:0xf bank_mask:0x3
    v_add_f32_dpp v144, v144, v144 row_ror:8 row_mask:0xf bank_mask:0x3
    v_add_f32_dpp v148, v148, v148 row_ror:8 row_mask:0xf bank_mask:0x3
    v_add_f32_dpp v128, v128, v128 row_half_mirror row_mask:0xf bank_mask:0x5
    v_add_f32_dpp v132, v132, v132 row_half_mirror row_mask:0xf bank_mask:0x5
    v_add_f32_dpp v136, v136, v136 row_half_mirror row_mask:0xf bank_mask:0x5
    v_add_f32_dpp v140, v140, v140 row_half_mirror row_mask:0xf bank_mask:0x5
    v_add_f32_dpp v128, v144, v144 row_half_mirror row_mask:0xf bank_mask:0xa
    v_add_f32_dpp v132, v148, v148 row_half_mirror row_mask:0xf bank_mask:0xa
    s_nop 0
    v_add_f32_dpp v128, v128, v128 quad_perm:[2,3,0,1] row_mask:0xf bank_mask:0xf
    v_add_f32_dpp v132, v132, v132 quad_perm:[2,3,0,1] row_mask:0xf bank_mask:0xf
    v_add_f32_dpp v136, v136, v136 quad_perm:[2,3,0,1] row_mask:0xf bank_mask:0xf
    v_add_f32_dpp v140, v140, v140 quad_perm:[2,3,0,1] row_mask:0xf bank_mask:0xf
    s_mov_b32 s8, 0xcccccccc
    s_mov_b32 s9, 0xcccccccc
    s_mov_b32 s10, 0xaaaaaaaa
    s_mov_b32 s11, 0xaaaaaaaa
    v_cndmask_b32 v128, v128, v136, s[8:9]
    v_cndmask_b32 v132, v132, v140, s[8:9]
    s_nop 0
    v_add_f32_dpp v128, v128, v128 quad_perm:[1,0,3,2] row_mask:0xf bank_mask:0xf
    v_add_f32_dpp v132, v132, v132 quad_perm:[1,0,3,2] row_mask:0xf bank_mask:0xf
    v_cndmask_b32 v41, v128, v132, s[10:11]
    s_mov_b32 s7, 0x3e0293ee
    v_mul_f32 v40, s7, v40
    v_mul_f32 v41, s7, v41
    v_mov_b32 v29, 0xff800000
    s_and_b32 s8, s6, 15
    s_sub_u32 s8, 21, s8
    s_cmp_lt_u32 s3, 1
    s_cselect_b32 s8, 63, s8
    v_cmp_ne_u32 vcc, s8, v2
    s_nop 1
    v_cndmask_b32 v40, v29, v40, vcc
    s_sub_u32 s8, s8, 16
    v_cmp_ne_u32 vcc, s8, v2
    s_nop 1
    v_cndmask_b32 v41, v29, v41, vcc
    v_cmp_gt_u32 vcc, 6, v2
    s_nop 1
    v_cndmask_b32 v41, v29, v41, vcc
    v_max_f32 v44, v40, v41
    s_nop 1
    v_max_f32_dpp v44, v44, v44 row_ror:8 row_mask:0xf bank_mask:0xf
    s_nop 1
    v_max_f32_dpp v44, v44, v44 row_ror:4 row_mask:0xf bank_mask:0xf
    s_nop 1
    v_max_f32_dpp v44, v44, v44 row_ror:2 row_mask:0xf bank_mask:0xf
    s_nop 1
    v_max_f32_dpp v44, v44, v44 row_ror:1 row_mask:0xf bank_mask:0xf
    v_mov_b32 v29, v44
    s_nop 1
    v_permlane16_swap_b32 v44, v29
    v_max_f32 v44, v44, v29
    v_mov_b32 v29, v44
    s_nop 1
    v_permlane32_swap_b32 v44, v29
    v_max_f32 v44, v44, v29
    v_sub_f32 v40, v40, v44
    v_sub_f32 v41, v41, v44
    v_exp_f32 v40, v40
    v_exp_f32 v41, v41
    v_cvt_pk_bf16_f32 v42, v40, v40
    v_cvt_pk_bf16_f32 v43, v41, v41
    v_lshlrev_b32 v40, 16, v42
    v_lshlrev_b32 v41, 16, v43
    v_add_f32 v45, v40, v41
    s_nop 1
    v_add_f32_dpp v45, v45, v45 row_ror:8 row_mask:0xf bank_mask:0xf
    s_nop 1
    v_add_f32_dpp v45, v45, v45 row_ror:4 row_mask:0xf bank_mask:0xf
    s_nop 1
    v_add_f32_dpp v45, v45, v45 row_ror:2 row_mask:0xf bank_mask:0xf
    s_nop 1
    v_add_f32_dpp v45, v45, v45 row_ror:1 row_mask:0xf bank_mask:0xf
    v_mov_b32 v29, v45
    s_nop 1
    v_permlane16_swap_b32 v45, v29
    v_add_f32 v45, v45, v29
    v_mov_b32 v29, v45
    s_nop 1
    v_permlane32_swap_b32 v45, v29
    v_add_f32 v45, v45, v29
    s_lshl_b32 s7, s3, 3
    v_mov_b32 v29, s7
    s_mov_b32 exec_lo, 0x1
    s_mov_b32 exec_hi, 0x0
    ds_write_b64 v29, v[44:45] offset:12544
    s_mov_b64 exec, -1
    s_waitcnt lgkmcnt(0)
    s_barrier
    s_cmp_lg_u32 s3, 0
    s_cbranch_scc1 L_nc_20
    s_setprio 2
    v_and_b32 v29, 7, v0
    v_lshlrev_b32 v30, 3, v29
    ds_read_b64 v[32:33], v30 offset:12544
    s_waitcnt lgkmcnt(0)
    v_mov_b32 v47, v32
    v_mov_b32 v34, v32
    s_nop 1
    v_max_f32_dpp v34, v34, v34 row_ror:4 row_mask:0xf bank_mask:0xf
    s_nop 1
    v_max_f32_dpp v34, v34, v34 row_ror:2 row_mask:0xf bank_mask:0xf
    s_nop 1
    v_max_f32_dpp v34, v34, v34 row_ror:1 row_mask:0xf bank_mask:0xf
    v_sub_f32 v35, v32, v34
    v_exp_f32 v35, v35
    s_nop 0
    v_mul_f32 v35, v35, v33
    s_nop 1
    v_add_f32_dpp v35, v35, v35 row_ror:4 row_mask:0xf bank_mask:0xf
    s_nop 1
    v_add_f32_dpp v35, v35, v35 row_ror:2 row_mask:0xf bank_mask:0xf
    s_nop 1
    v_add_f32_dpp v35, v35, v35 row_ror:1 row_mask:0xf bank_mask:0xf
    v_mov_b32 v36, v34
    v_mov_b32 v37, s4
    v_mov_b32 v38, v35
    v_mov_b32 v39, s4
    s_lshl_b32 s8, s6, 7
    s_add_u32 s8, s8, 4096
    s_lshl_b32 s9, s5, 4
    s_add_u32 s9, s9, s8
    v_mov_b32 v30, 0
    s_mov_b32 exec_lo, 0x1
    s_mov_b32 exec_hi, 0x0
    buffer_store_dwordx4 v[36:39], v30, s[48:51], s9 offen sc1
    s_mov_b64 exec, -1
    s_setprio 0
L_nc_20:
    v_and_b32_dpp v16, v42, v4 row_newbcast:0 row_mask:0xf bank_mask:0xf
    v_and_b32_dpp v17, v42, v5 row_newbcast:0 row_mask:0xf bank_mask:0xf
    v_and_b32_dpp v18, v42, v6 row_newbcast:0 row_mask:0xf bank_mask:0xf
    v_and_b32_dpp v19, v42, v7 row_newbcast:0 row_mask:0xf bank_mask:0xf
    s_waitcnt vmcnt(4)
    s_nop 0
    v_mfma_f32_16x16x32_bf16 v[12:15], v[16:19], v[152:155], 0
    v_and_b32_dpp v20, v42, v4 row_newbcast:1 row_mask:0xf bank_mask:0xf
    v_and_b32_dpp v21, v42, v5 row_newbcast:1 row_mask:0xf bank_mask:0xf
    v_and_b32_dpp v22, v42, v6 row_newbcast:1 row_mask:0xf bank_mask:0xf
    v_and_b32_dpp v23, v42, v7 row_newbcast:1 row_mask:0xf bank_mask:0xf
    s_waitcnt vmcnt(3)
    s_nop 0
    v_mfma_f32_16x16x32_bf16 v[12:15], v[20:23], v[156:159], v[12:15]
    v_and_b32_dpp v16, v42, v4 row_newbcast:2 row_mask:0xf bank_mask:0xf
    v_and_b32_dpp v17, v42, v5 row_newbcast:2 row_mask:0xf bank_mask:0xf
    v_and_b32_dpp v18, v42, v6 row_newbcast:2 row_mask:0xf bank_mask:0xf
    v_and_b32_dpp v19, v42, v7 row_newbcast:2 row_mask:0xf bank_mask:0xf
    buffer_load_dwordx4 v[172:175], v24, s[56:59], s73 offen nt
    s_addk_i32 s73, 0x2000
    s_cmp_eq_u32 s73, 180224
    s_cselect_b32 s73, 0, s73
    s_waitcnt vmcnt(3)
    v_mfma_f32_16x16x32_bf16 v[12:15], v[16:19], v[160:163], v[12:15]
    v_and_b32_dpp v20, v42, v4 row_newbcast:3 row_mask:0xf bank_mask:0xf
    v_and_b32_dpp v21, v42, v5 row_newbcast:3 row_mask:0xf bank_mask:0xf
    v_and_b32_dpp v22, v42, v6 row_newbcast:3 row_mask:0xf bank_mask:0xf
    v_and_b32_dpp v23, v42, v7 row_newbcast:3 row_mask:0xf bank_mask:0xf
    buffer_load_dwordx4 v[176:179], v24, s[56:59], s73 offen nt
    s_addk_i32 s73, 0x2000
    s_cmp_eq_u32 s73, 180224
    s_cselect_b32 s73, 0, s73
    s_waitcnt vmcnt(3)
    v_mfma_f32_16x16x32_bf16 v[12:15], v[20:23], v[164:167], v[12:15]
    v_and_b32_dpp v16, v42, v4 row_newbcast:4 row_mask:0xf bank_mask:0xf
    v_and_b32_dpp v17, v42, v5 row_newbcast:4 row_mask:0xf bank_mask:0xf
    v_and_b32_dpp v18, v42, v6 row_newbcast:4 row_mask:0xf bank_mask:0xf
    v_and_b32_dpp v19, v42, v7 row_newbcast:4 row_mask:0xf bank_mask:0xf
    buffer_load_dwordx4 v[180:183], v24, s[56:59], s73 offen nt
    s_addk_i32 s73, 0x2000
    s_cmp_eq_u32 s73, 180224
    s_cselect_b32 s73, 0, s73
    s_waitcnt vmcnt(3)
    v_mfma_f32_16x16x32_bf16 v[12:15], v[16:19], v[168:171], v[12:15]
    v_and_b32_dpp v20, v42, v4 row_newbcast:5 row_mask:0xf bank_mask:0xf
    v_and_b32_dpp v21, v42, v5 row_newbcast:5 row_mask:0xf bank_mask:0xf
    v_and_b32_dpp v22, v42, v6 row_newbcast:5 row_mask:0xf bank_mask:0xf
    v_and_b32_dpp v23, v42, v7 row_newbcast:5 row_mask:0xf bank_mask:0xf
    buffer_load_dwordx4 v[184:187], v24, s[56:59], s73 offen nt
    s_addk_i32 s73, 0x2000
    s_cmp_eq_u32 s73, 180224
    s_cselect_b32 s73, 0, s73
    s_waitcnt vmcnt(3)
    v_mfma_f32_16x16x32_bf16 v[12:15], v[20:23], v[172:175], v[12:15]
    v_and_b32_dpp v16, v42, v4 row_newbcast:6 row_mask:0xf bank_mask:0xf
    v_and_b32_dpp v17, v42, v5 row_newbcast:6 row_mask:0xf bank_mask:0xf
    v_and_b32_dpp v18, v42, v6 row_newbcast:6 row_mask:0xf bank_mask:0xf
    v_and_b32_dpp v19, v42, v7 row_newbcast:6 row_mask:0xf bank_mask:0xf
    buffer_load_dwordx4 v[188:191], v24, s[56:59], s73 offen nt
    s_addk_i32 s73, 0x2000
    s_cmp_eq_u32 s73, 180224
    s_cselect_b32 s73, 0, s73
    s_waitcnt vmcnt(3)
    v_mfma_f32_16x16x32_bf16 v[12:15], v[16:19], v[176:179], v[12:15]
    v_and_b32_dpp v20, v42, v4 row_newbcast:7 row_mask:0xf bank_mask:0xf
    v_and_b32_dpp v21, v42, v5 row_newbcast:7 row_mask:0xf bank_mask:0xf
    v_and_b32_dpp v22, v42, v6 row_newbcast:7 row_mask:0xf bank_mask:0xf
    v_and_b32_dpp v23, v42, v7 row_newbcast:7 row_mask:0xf bank_mask:0xf
    s_cmp_lg_u32 s3, 0
    s_nop 2
    s_cbranch_scc1 L_nc_21
    v_and_b32 v29, 7, v0
    v_min_u32 v29, 5, v29
    v_lshlrev_b32 v29, 4, v29
    s_lshl_b32 s8, s6, 7
    s_add_u32 s8, s8, 4096
    buffer_load_dwordx4 v[36:39], v29, s[48:51], s8 offen sc1
L_nc_21:
    buffer_load_dwordx4 v[192:195], v24, s[56:59], s73 offen nt
    s_addk_i32 s73, 0x2000
    s_cmp_eq_u32 s73, 180224
    s_cselect_b32 s73, 0, s73
    s_waitcnt vmcnt(3)
    v_mfma_f32_16x16x32_bf16 v[12:15], v[20:23], v[180:183], v[12:15]
    v_and_b32_dpp v16, v42, v4 row_newbcast:8 row_mask:0xf bank_mask:0xf
    v_and_b32_dpp v17, v42, v5 row_newbcast:8 row_mask:0xf bank_mask:0xf
    v_and_b32_dpp v18, v42, v6 row_newbcast:8 row_mask:0xf bank_mask:0xf
    v_and_b32_dpp v19, v42, v7 row_newbcast:8 row_mask:0xf bank_mask:0xf
    buffer_load_dwordx4 v[196:199], v24, s[56:59], s73 offen nt
    s_addk_i32 s73, 0x2000
    s_cmp_eq_u32 s73, 180224
    s_cselect_b32 s73, 0, s73
    s_waitcnt vmcnt(3)
    v_mfma_f32_16x16x32_bf16 v[12:15], v[16:19], v[184:187], v[12:15]
    v_and_b32_dpp v20, v42, v4 row_newbcast:9 row_mask:0xf bank_mask:0xf
    v_and_b32_dpp v21, v42, v5 row_newbcast:9 row_mask:0xf bank_mask:0xf
    v_and_b32_dpp v22, v42, v6 row_newbcast:9 row_mask:0xf bank_mask:0xf
    v_and_b32_dpp v23, v42, v7 row_newbcast:9 row_mask:0xf bank_mask:0xf
    buffer_load_dwordx4 v[200:203], v24, s[56:59], s73 offen nt
    s_addk_i32 s73, 0x2000
    s_cmp_eq_u32 s73, 180224
    s_cselect_b32 s73, 0, s73
    s_waitcnt vmcnt(3)
    v_mfma_f32_16x16x32_bf16 v[12:15], v[20:23], v[188:191], v[12:15]
    v_and_b32_dpp v16, v42, v4 row_newbcast:10 row_mask:0xf bank_mask:0xf
    v_and_b32_dpp v17, v42, v5 row_newbcast:10 row_mask:0xf bank_mask:0xf
    v_and_b32_dpp v18, v42, v6 row_newbcast:10 row_mask:0xf bank_mask:0xf
    v_and_b32_dpp v19, v42, v7 row_newbcast:10 row_mask:0xf bank_mask:0xf
    buffer_load_dwordx4 v[204:207], v24, s[56:59], s73 offen nt
    s_addk_i32 s73, 0x2000
    s_cmp_eq_u32 s73, 180224
    s_cselect_b32 s73, 0, s73
    s_waitcnt vmcnt(3)
    v_mfma_f32_16x16x32_bf16 v[12:15], v[16:19], v[192:195], v[12:15]
    v_and_b32_dpp v20, v42, v4 row_newbcast:11 row_mask:0xf bank_mask:0xf
    v_and_b32_dpp v21, v42, v5 row_newbcast:11 row_mask:0xf bank_mask:0xf
    v_and_b32_dpp v22, v42, v6 row_newbcast:11 row_mask:0xf bank_mask:0xf
    v_and_b32_dpp v23, v42, v7 row_newbcast:11 row_mask:0xf bank_mask:0xf
    buffer_load_dwordx4 v[208:211], v24, s[56:59], s73 offen nt
    s_addk_i32 s73, 0x2000
    s_cmp_eq_u32 s73, 180224
    s_cselect_b32 s73, 0, s73
    s_waitcnt vmcnt(3)
    v_mfma_f32_16x16x32_bf16 v[12:15], v[20:23], v[196:199], v[12:15]
    v_and_b32_dpp v16, v42, v4 row_newbcast:12 row_mask:0xf bank_mask:0xf
    v_and_b32_dpp v17, v42, v5 row_newbcast:12 row_mask:0xf bank_mask:0xf
    v_and_b32_dpp v18, v42, v6 row_newbcast:12 row_mask:0xf bank_mask:0xf
    v_and_b32_dpp v19, v42, v7 row_newbcast:12 row_mask:0xf bank_mask:0xf
    buffer_load_dwordx4 v[212:215], v24, s[56:59], s73 offen nt
    s_addk_i32 s73, 0x2000
    s_cmp_eq_u32 s73, 180224
    s_cselect_b32 s73, 0, s73
    s_waitcnt vmcnt(3)
    v_mfma_f32_16x16x32_bf16 v[12:15], v[16:19], v[200:203], v[12:15]
    v_and_b32_dpp v20, v42, v4 row_newbcast:13 row_mask:0xf bank_mask:0xf
    v_and_b32_dpp v21, v42, v5 row_newbcast:13 row_mask:0xf bank_mask:0xf
    v_and_b32_dpp v22, v42, v6 row_newbcast:13 row_mask:0xf bank_mask:0xf
    v_and_b32_dpp v23, v42, v7 row_newbcast:13 row_mask:0xf bank_mask:0xf
    buffer_load_dwordx4 v[216:219], v24, s[56:59], s73 offen nt
    s_addk_i32 s73, 0x2000
    s_cmp_eq_u32 s73, 180224
    s_cselect_b32 s73, 0, s73
    s_waitcnt vmcnt(3)
    v_mfma_f32_16x16x32_bf16 v[12:15], v[20:23], v[204:207], v[12:15]
    v_and_b32_dpp v16, v42, v4 row_newbcast:14 row_mask:0xf bank_mask:0xf
    v_and_b32_dpp v17, v42, v5 row_newbcast:14 row_mask:0xf bank_mask:0xf
    v_and_b32_dpp v18, v42, v6 row_newbcast:14 row_mask:0xf bank_mask:0xf
    v_and_b32_dpp v19, v42, v7 row_newbcast:14 row_mask:0xf bank_mask:0xf
    buffer_load_dwordx4 v[220:223], v24, s[56:59], s73 offen nt
    s_addk_i32 s73, 0x2000
    s_cmp_eq_u32 s73, 180224
    s_cselect_b32 s73, 0, s73
    s_waitcnt vmcnt(3)
    v_mfma_f32_16x16x32_bf16 v[12:15], v[16:19], v[208:211], v[12:15]
    v_and_b32_dpp v20, v42, v4 row_newbcast:15 row_mask:0xf bank_mask:0xf
    v_and_b32_dpp v21, v42, v5 row_newbcast:15 row_mask:0xf bank_mask:0xf
    v_and_b32_dpp v22, v42, v6 row_newbcast:15 row_mask:0xf bank_mask:0xf
    v_and_b32_dpp v23, v42, v7 row_newbcast:15 row_mask:0xf bank_mask:0xf
    buffer_load_dwordx4 v[224:227], v24, s[56:59], s73 offen nt
    s_addk_i32 s73, 0x2000
    s_cmp_eq_u32 s73, 180224
    s_cselect_b32 s73, 0, s73
    s_waitcnt vmcnt(3)
    v_mfma_f32_16x16x32_bf16 v[12:15], v[20:23], v[212:215], v[12:15]
    v_and_b32_dpp v16, v43, v4 row_newbcast:0 row_mask:0xf bank_mask:0xf
    v_and_b32_dpp v17, v43, v5 row_newbcast:0 row_mask:0xf bank_mask:0xf
    v_and_b32_dpp v18, v43, v6 row_newbcast:0 row_mask:0xf bank_mask:0xf
    v_and_b32_dpp v19, v43, v7 row_newbcast:0 row_mask:0xf bank_mask:0xf
    buffer_load_dwordx4 v[228:231], v24, s[56:59], s73 offen nt
    s_addk_i32 s73, 0x2000
    s_cmp_eq_u32 s73, 180224
    s_cselect_b32 s73, 0, s73
    s_waitcnt vmcnt(3)
    v_mfma_f32_16x16x32_bf16 v[12:15], v[16:19], v[216:219], v[12:15]
    v_and_b32_dpp v20, v43, v4 row_newbcast:1 row_mask:0xf bank_mask:0xf
    v_and_b32_dpp v21, v43, v5 row_newbcast:1 row_mask:0xf bank_mask:0xf
    v_and_b32_dpp v22, v43, v6 row_newbcast:1 row_mask:0xf bank_mask:0xf
    v_and_b32_dpp v23, v43, v7 row_newbcast:1 row_mask:0xf bank_mask:0xf
    buffer_load_dwordx4 v[232:235], v24, s[56:59], s73 offen nt
    s_addk_i32 s73, 0x2000
    s_cmp_eq_u32 s73, 180224
    s_cselect_b32 s73, 0, s73
    s_waitcnt vmcnt(3)
    v_mfma_f32_16x16x32_bf16 v[12:15], v[20:23], v[220:223], v[12:15]
    v_and_b32_dpp v16, v43, v4 row_newbcast:2 row_mask:0xf bank_mask:0xf
    v_and_b32_dpp v17, v43, v5 row_newbcast:2 row_mask:0xf bank_mask:0xf
    v_and_b32_dpp v18, v43, v6 row_newbcast:2 row_mask:0xf bank_mask:0xf
    v_and_b32_dpp v19, v43, v7 row_newbcast:2 row_mask:0xf bank_mask:0xf
    s_cmp_lg_u32 s3, 0
    s_nop 2
    s_cbranch_scc1 L_nc_22
    s_mov_b32 s15, 0
L_mlchk_23:
    v_xor_b32 v37, s4, v37
    v_xor_b32 v39, s4, v39
    v_or_b32 v30, v37, v39
    v_cmp_ne_u32 vcc, 0, v30
    s_nop 0
    s_cmp_eq_u64 vcc, 0
    s_nop 2
    s_cbranch_scc1 L_mldone_24
    s_add_u32 s15, s15, 1
    s_cmp_gt_u32 s15, 200000
    s_cbranch_scc1 L_mldone_24
    v_and_b32 v29, 7, v0
    v_min_u32 v29, 5, v29
    v_lshlrev_b32 v29, 4, v29
    s_lshl_b32 s8, s6, 7
    s_add_u32 s8, s8, 4096
    buffer_load_dwordx4 v[36:39], v29, s[48:51], s8 offen sc1
    s_waitcnt vmcnt(0)
    s_branch L_mlchk_23
L_mldone_24:
    v_and_b32 v29, 7, v0
    v_cmp_gt_u32 vcc, 6, v29
    s_nop 1
    v_cndmask_b32 v38, 0, v38, vcc
    v_mov_b32 v31, v36
    s_nop 1
    v_max_f32_dpp v31, v31, v31 row_ror:4 row_mask:0xf bank_mask:0xf
    s_nop 1
    v_max_f32_dpp v31, v31, v31 row_ror:2 row_mask:0xf bank_mask:0xf
    s_nop 1
    v_max_f32_dpp v31, v31, v31 row_ror:1 row_mask:0xf bank_mask:0xf
    v_sub_f32 v32, v36, v31
    v_exp_f32 v32, v32
    s_nop 0
    v_mul_f32 v32, v32, v38
    s_nop 1
    v_add_f32_dpp v32, v32, v32 row_ror:4 row_mask:0xf bank_mask:0xf
    s_nop 1
    v_add_f32_dpp v32, v32, v32 row_ror:2 row_mask:0xf bank_mask:0xf
    s_nop 1
    v_add_f32_dpp v32, v32, v32 row_ror:1 row_mask:0xf bank_mask:0xf
    v_rcp_f32 v32, v32
    v_sub_f32 v33, v47, v31
    v_exp_f32 v33, v33
    s_nop 0
    v_mul_f32 v33, v33, v32
    s_nop 0
    v_readlane_b32 s92, v33, 0
    v_readlane_b32 s93, v33, 1
    v_readlane_b32 s94, v33, 2
    v_readlane_b32 s95, v33, 3
    v_readlane_b32 s96, v33, 4
    v_readlane_b32 s97, v33, 5
    v_readlane_b32 s98, v33, 6
    v_readlane_b32 s99, v33, 7
    s_nop 4
L_nc_22:
    buffer_load_dwordx4 v[236:239], v24, s[56:59], s73 offen nt
    s_addk_i32 s73, 0x2000
    s_cmp_eq_u32 s73, 180224
    s_cselect_b32 s73, 0, s73
    s_waitcnt vmcnt(3)
    v_mfma_f32_16x16x32_bf16 v[12:15], v[16:19], v[224:227], v[12:15]
    v_and_b32_dpp v20, v43, v4 row_newbcast:3 row_mask:0xf bank_mask:0xf
    v_and_b32_dpp v21, v43, v5 row_newbcast:3 row_mask:0xf bank_mask:0xf
    v_and_b32_dpp v22, v43, v6 row_newbcast:3 row_mask:0xf bank_mask:0xf
    v_and_b32_dpp v23, v43, v7 row_newbcast:3 row_mask:0xf bank_mask:0xf
    s_waitcnt vmcnt(2)
    s_nop 0
    v_mfma_f32_16x16x32_bf16 v[12:15], v[20:23], v[228:231], v[12:15]
    v_and_b32_dpp v16, v43, v4 row_newbcast:4 row_mask:0xf bank_mask:0xf
    v_and_b32_dpp v17, v43, v5 row_newbcast:4 row_mask:0xf bank_mask:0xf
    v_and_b32_dpp v18, v43, v6 row_newbcast:4 row_mask:0xf bank_mask:0xf
    v_and_b32_dpp v19, v43, v7 row_newbcast:4 row_mask:0xf bank_mask:0xf
    s_waitcnt vmcnt(1)
    s_nop 0
    v_mfma_f32_16x16x32_bf16 v[12:15], v[16:19], v[232:235], v[12:15]
    v_and_b32_dpp v20, v43, v4 row_newbcast:5 row_mask:0xf bank_mask:0xf
    v_and_b32_dpp v21, v43, v5 row_newbcast:5 row_mask:0xf bank_mask:0xf
    v_and_b32_dpp v22, v43, v6 row_newbcast:5 row_mask:0xf bank_mask:0xf
    v_and_b32_dpp v23, v43, v7 row_newbcast:5 row_mask:0xf bank_mask:0xf
    s_waitcnt vmcnt(0)
    s_nop 0
    v_mfma_f32_16x16x32_bf16 v[12:15], v[20:23], v[236:239], v[12:15]
    s_mov_b32 exec_lo, 0xffffffff
    s_mov_b32 exec_hi, 0x0
    s_nop 5
    ds_write_b128 v27, v[12:15] offset:4096
    s_mov_b64 exec, -1
    s_waitcnt lgkmcnt(0)
    s_barrier
    s_cmp_lg_u32 s3, 0
    s_cbranch_scc1 L_nc_25
    s_setprio 2
    v_lshlrev_b32 v29, 3, v0
    ds_read_b64 v[64:65], v29 offset:4096
    ds_read_b64 v[66:67], v29 offset:4608
    ds_read_b64 v[68:69], v29 offset:5120
    ds_read_b64 v[70:71], v29 offset:5632
    ds_read_b64 v[72:73], v29 offset:6144
    ds_read_b64 v[74:75], v29 offset:6656
    ds_read_b64 v[76:77], v29 offset:7168
    ds_read_b64 v[78:79], v29 offset:7680
    s_mul_i32 s8, s6, 6
    s_add_u32 s9, s8, s5
    s_lshl_b32 s9, s9, 10
    s_add_u32 s9, s9, 204800
    v_mov_b32 v37, s4
    v_mov_b32 v39, s4
    s_waitcnt lgkmcnt(0)
    v_mul_f32 v36, s92, v64
    v_mul_f32 v38, s92, v65
    v_mul_f32 v30, s93, v66
    v_mul_f32 v31, s93, v67
    v_fmac_f32 v36, s94, v68
    v_fmac_f32 v38, s94, v69
    v_fmac_f32 v30, s95, v70
    v_fmac_f32 v31, s95, v71
    v_fmac_f32 v36, s96, v72
    v_fmac_f32 v38, s96, v73
    v_fmac_f32 v30, s97, v74
    v_fmac_f32 v31, s97, v75
    v_fmac_f32 v36, s98, v76
    v_fmac_f32 v38, s98, v77
    v_fmac_f32 v30, s99, v78
    v_fmac_f32 v31, s99, v79
    v_add_f32 v36, v36, v30
    v_add_f32 v38, v38, v31
    s_add_u32 s8, s9, 2940928
    buffer_store_dwordx4 v[36:39], v28, s[48:51], s8 offen
    buffer_store_dwordx4 v[36:39], v28, s[48:51], s9 offen sc1
    s_setprio 0
    s_nop 0
L_nc_25:
    s_mov_b32 s14, s6
    s_cmp_eq_u32 s3, 1
    s_cbranch_scc1 L_bgo_27
    s_cmp_lg_u32 s3, 2
    s_cbranch_scc1 L_bfin_26
    s_cmp_ge_u32 s6, 8
    s_cbranch_scc1 L_bfin_26
    s_add_u32 s14, s14, 32
L_bgo_27:
    s_mov_b32 s68, s42
    s_mov_b32 s69, s43
    s_mov_b32 s70, 2560
    s_mov_b32 s71, 0x20000
    s_lshr_b32 s7, s14, 3
    s_lshl_b32 s7, s7, 15
    s_and_b32 s8, s14, 7
    s_lshl_b32 s8, s8, 7
    s_add_u32 s7, s7, s8
    s_add_u32 s10, s7, 401408
    s_lshl_b32 s14, s14, 5
    s_add_u32 s14, s14, 1280
    v_lshrrev_b32 v29, 3, v0
    v_mul_u32_u24 v29, 1024, v29
    v_and_b32 v30, 7, v0
    v_lshlrev_b32 v30, 4, v30
    v_add_u32 v29, v29, v30
    s_mov_b32 s15, 0
    s_mov_b32 s7, s10
    buffer_load_dwordx4 v[64:67], v29, s[48:51], s7 offen sc1
    s_add_u32 s7, s7, 8192
    buffer_load_dwordx4 v[68:71], v29, s[48:51], s7 offen sc1
    s_add_u32 s7, s7, 8192
    buffer_load_dwordx4 v[72:75], v29, s[48:51], s7 offen sc1
    s_add_u32 s7, s7, 8192
    buffer_load_dwordx4 v[76:79], v29, s[48:51], s7 offen sc1
L_pl_28:
    s_mov_b32 s7, s10
    buffer_load_dwordx4 v[80:83], v29, s[48:51], s7 offen sc1
    s_add_u32 s7, s7, 8192
    buffer_load_dwordx4 v[84:87], v29, s[48:51], s7 offen sc1
    s_add_u32 s7, s7, 8192
    buffer_load_dwordx4 v[88:91], v29, s[48:51], s7 offen sc1
    s_add_u32 s7, s7, 8192
    buffer_load_dwordx4 v[92:95], v29, s[48:51], s7 offen sc1
    s_waitcnt vmcnt(4)
    v_xor_b32 v65, s4, v65
    v_xor_b32 v67, s4, v67
    v_or_b32 v31, v65, v67
    v_xor_b32 v69, s4, v69
    v_xor_b32 v71, s4, v71
    v_or3_b32 v31, v31, v69, v71
    v_xor_b32 v73, s4, v73
    v_xor_b32 v75, s4, v75
    v_or3_b32 v31, v31, v73, v75
    v_xor_b32 v77, s4, v77
    v_xor_b32 v79, s4, v79
    v_or3_b32 v31, v31, v77, v79
    v_cmp_ne_u32 vcc, 0, v31
    s_nop 0
    s_cmp_eq_u64 vcc, 0
    s_cbranch_scc1 L_ok0_29
    s_mov_b32 s7, s10
    buffer_load_dwordx4 v[64:67], v29, s[48:51], s7 offen sc1
    s_add_u32 s7, s7, 8192
    buffer_load_dwordx4 v[68:71], v29, s[48:51], s7 offen sc1
    s_add_u32 s7, s7, 8192
    buffer_load_dwordx4 v[72:75], v29, s[48:51], s7 offen sc1
    s_add_u32 s7, s7, 8192
    buffer_load_dwordx4 v[76:79], v29, s[48:51], s7 offen sc1
    s_waitcnt vmcnt(4)
    v_xor_b32 v81, s4, v81
    v_xor_b32 v83, s4, v83
    v_or_b32 v31, v81, v83
    v_xor_b32 v85, s4, v85
    v_xor_b32 v87, s4, v87
    v_or3_b32 v31, v31, v85, v87
    v_xor_b32 v89, s4, v89
    v_xor_b32 v91, s4, v91
    v_or3_b32 v31, v31, v89, v91
    v_xor_b32 v93, s4, v93
    v_xor_b32 v95, s4, v95
    v_or3_b32 v31, v31, v93, v95
    v_cmp_ne_u32 vcc, 0, v31
    s_nop 0
    s_cmp_eq_u64 vcc, 0
    s_cbranch_scc1 L_ok1_30
    s_add_u32 s15, s15, 1
    s_cmp_le_u32 s15, 200000
    s_cbranch_scc1 L_pl_28
L_ok1_30:
    v_add_f32 v80, v80, v88
    v_add_f32 v82, v82, v90
    v_add_f32 v84, v84, v92
    v_add_f32 v86, v86, v94
    v_add_f32 v96, v80, v84
    v_add_f32 v98, v82, v86
    s_branch L_pout_31
    s_nop 0
L_ok0_29:
    v_add_f32 v64, v64, v72
    v_add_f32 v66, v66, v74
    v_add_f32 v68, v68, v76
    v_add_f32 v70, v70, v78
    v_add_f32 v96, v64, v68
    v_add_f32 v98, v66, v70
    s_nop 1
L_pout_31:
    v_add_f32_dpp v96, v96, v96 row_ror:8 row_mask:0xf bank_mask:0xf
    v_add_f32_dpp v98, v98, v98 row_ror:8 row_mask:0xf bank_mask:0xf
    v_mov_b32 v31, v96
    v_mov_b32 v32, v98
    s_nop 0
    v_permlane16_swap_b32 v96, v31
    v_permlane16_swap_b32 v98, v32
    v_add_f32 v96, v96, v31
    v_add_f32 v98, v98, v32
    v_mov_b32 v31, v96
    v_mov_b32 v32, v98
    s_nop 0
    v_permlane32_swap_b32 v96, v31
    v_permlane32_swap_b32 v98, v32
    v_add_f32 v96, v96, v31
    v_add_f32 v98, v98, v32
    v_cvt_pk_bf16_f32 v96, v96, v98
    v_lshlrev_b32 v29, 2, v0
    s_mov_b32 exec_lo, 0xff
    s_mov_b32 exec_hi, 0x0
    buffer_store_dword v96, v29, s[68:71], s14 offen
    s_mov_b64 exec, -1
    s_nop 0
L_bfin_26:
    s_endpgm
L_A:
    s_lshr_b32 s7, s2, 3
    s_and_b32 s8, s2, 7
    s_lshl_b32 s8, s8, 3
    s_add_u32 s76, s7, s8
    s_lshr_b32 s6, s76, 1
    s_and_b32 s5, s76, 1
    s_and_b32 s12, s2, 7
    s_lshr_b32 s7, s2, 4
    s_lshl_b32 s7, s7, 3
    s_add_u32 s12, s12, s7
    s_lshr_b32 s13, s2, 3
    s_and_b32 s13, s13, 1
    s_mov_b32 s100, s2
    s_lshl_b32 s101, s13, 3
    s_add_u32 s101, s101, s12
    s_add_u32 s77, s5, 6
    v_lshlrev_b32 v25, 13, v1
    v_lshlrev_b32 v36, 4, v2
    v_add_u32 v25, v25, v36
    s_mul_i32 s7, s77, 80
    s_and_b32 s8, s3, 3
    s_mul_i32 s8, s8, 20
    s_add_u32 s7, s7, s8
    v_add_u32 v24, s7, v1
    v_lshlrev_b32 v24, 1, v24
    s_lshl_b32 s14, s7, 13
    s_lshl_b32 s8, s6, 8
    s_add_u32 s14, s14, s8
    s_waitcnt lgkmcnt(0)
    s_cmp_lt_u32 s3, 4
    s_cselect_b32 s52, s16, s32
    s_cselect_b32 s53, s17, s33
    s_cselect_b32 s8, s20, s38
    s_cselect_b32 s9, s21, s39
    s_mov_b32 s54, 1280
    s_mov_b32 s55, 0x20000
    s_add_u32 s56, s8, s14
    s_addc_u32 s57, s9, 0
    s_mov_b32 s58, 163840
    s_mov_b32 s59, 0x20000
    buffer_load_ushort v192, v24, s[52:55], 0 offen offset:0
    buffer_load_ushort v193, v24, s[52:55], 0 offen offset:8
    buffer_load_ushort v194, v24, s[52:55], 0 offen offset:16
    buffer_load_ushort v195, v24, s[52:55], 0 offen offset:24
    buffer_load_ushort v196, v24, s[52:55], 0 offen offset:32
    s_mov_b32 s7, 0
    buffer_load_dwordx4 v[48:51], v25, s[56:59], s7 offen nt
    s_mov_b32 s7, 32768
    buffer_load_dwordx4 v[52:55], v25, s[56:59], s7 offen nt
    s_mov_b32 s7, 65536
    buffer_load_dwordx4 v[56:59], v25, s[56:59], s7 offen nt
    s_mov_b32 s7, 98304
    buffer_load_dwordx4 v[60:63], v25, s[56:59], s7 offen nt
    s_mov_b32 s7, 131072
    buffer_load_dwordx4 v[64:67], v25, s[56:59], s7 offen nt
    s_load_dword s4, s[46:47], 0
    s_lshl_b32 s7, s3, 5
    v_lshlrev_b32 v36, 3, v1
    v_add_u32 v36, s7, v36
    v_lshlrev_b32 v36, 13, v36
    v_lshlrev_b32 v37, 4, v2
    v_add_u32 v34, v36, v37
    s_lshl_b32 s9, s6, 8
    s_lshl_b32 s10, s5, 21
    s_add_u32 s9, s9, s10
    s_add_u32 s60, s22, s9
    s_addc_u32 s61, s23, 0
    s_mov_b32 s62, 2097152
    s_mov_b32 s63, 0x20000
    s_mov_b32 s7, 0
    buffer_load_dwordx4 v[88:91], v34, s[60:63], s7 offen nt
    s_mov_b32 s7, 8192
    buffer_load_dwordx4 v[92:95], v34, s[60:63], s7 offen nt
    s_mov_b32 s7, 16384
    buffer_load_dwordx4 v[96:99], v34, s[60:63], s7 offen nt
    s_mov_b32 s7, 24576
    buffer_load_dwordx4 v[100:103], v34, s[60:63], s7 offen nt
    v_lshrrev_b32 v3, 1, v2
    v_and_b32 v36, 1, v2
    v_lshlrev_b32 v36, 4, v36
    v_mov_b32 v37, 0xffff
    v_lshlrev_b32 v36, v36, v37
    v_cmp_eq_u32 vcc, 0, v3
    s_nop 1
    v_cndmask_b32 v8, 0, v36, vcc
    v_cmp_eq_u32 vcc, 1, v3
    s_nop 1
    v_cndmask_b32 v9, 0, v36, vcc
    v_cmp_eq_u32 vcc, 2, v3
    s_nop 1
    v_cndmask_b32 v10, 0, v36, vcc
    v_cmp_eq_u32 vcc, 3, v3
    s_nop 1
    v_cndmask_b32 v11, 0, v36, vcc
    s_lshl_b32 s9, s3, 9
    v_lshlrev_b32 v33, 5, v2
    v_lshlrev_b32 v37, 4, v1
    s_add_u32 s9, s9, 135168
    v_add3_u32 v33, v33, v37, s9
    v_lshrrev_b32 v29, 3, v0
    v_and_b32 v30, 7, v0
    v_lshrrev_b32 v3, 1, v30
    v_and_b32 v36, 1, v2
    v_lshlrev_b32 v36, 4, v36
    v_mov_b32 v37, 0xffff
    v_lshlrev_b32 v36, v36, v37
    v_cmp_eq_u32 vcc, 0, v3
    s_nop 1
    v_cndmask_b32 v4, 0, v36, vcc
    v_cmp_eq_u32 vcc, 1, v3
    s_nop 1
    v_cndmask_b32 v5, 0, v36, vcc
    v_cmp_eq_u32 vcc, 2, v3
    s_nop 1
    v_cndmask_b32 v6, 0, v36, vcc
    v_cmp_eq_u32 vcc, 3, v3
    s_nop 1
    v_cndmask_b32 v7, 0, v36, vcc
    s_lshl_b32 s7, s3, 6
    v_lshlrev_b32 v36, 3, v29
    v_add_u32 v36, s7, v36
    v_lshlrev_b32 v36, 13, v36
    v_lshlrev_b32 v37, 4, v30
    v_add_u32 v26, v36, v37
    s_lshl_b32 s7, s3, 3
    v_add_u32 v36, s7, v1
    v_mul_u32_u24 v36, 1280, v36
    v_lshlrev_b32 v37, 4, v2
    v_add_u32 v27, v36, v37
    v_lshlrev_b32 v28, 4, v0
    s_lshl_b32 s9, s6, 8
    s_lshl_b32 s10, s5, 7
    s_add_u32 s9, s9, s10
    s_add_u32 s64, s24, s9
    s_addc_u32 s65, s25, 0
    s_mov_b32 s66, 4194304
    s_mov_b32 s67, 0x20000
    s_mov_b32 s48, s46
    s_mov_b32 s49, s47
    s_mov_b32 s50, 3866624
    s_mov_b32 s51, 0x20000
    s_lshl_b32 s9, s6, 7
    s_lshl_b32 s10, s5, 6
    s_add_u32 s9, s9, s10
    s_mul_i32 s9, s9, 1280
    s_add_u32 s68, s26, s9
    s_addc_u32 s69, s27, 0
    s_mov_b32 s70, 81920
    s_mov_b32 s71, 0x20000
    s_lshl_b32 s9, s12, 17
    s_add_u32 s72, s18, s9
    s_addc_u32 s73, s19, 0
    s_mov_b32 s74, 131072
    s_mov_b32 s75, 0x20000
    s_waitcnt lgkmcnt(0)
    s_add_u32 s4, s4, 0x9e3779b1
    s_waitcnt vmcnt(8)
    v_lshl_or_b32 v192, v192, 16, v192
    v_and_b32 v16, v192, v8
    v_and_b32 v17, v192, v9
    v_and_b32 v18, v192, v10
    v_and_b32 v19, v192, v11
    s_nop 1
    v_mfma_f32_16x16x32_bf16 v[12:15], v[16:19], v[48:51], 0
    s_waitcnt vmcnt(7)
    v_lshl_or_b32 v193, v193, 16, v193
    v_and_b32 v20, v193, v8
    v_and_b32 v21, v193, v9
    v_and_b32 v22, v193, v10
    v_and_b32 v23, v193, v11
    s_nop 1
    v_mfma_f32_16x16x32_bf16 v[12:15], v[20:23], v[52:55], v[12:15]
    s_waitcnt vmcnt(6)
    v_lshl_or_b32 v194, v194, 16, v194
    v_and_b32 v16, v194, v8
    v_and_b32 v17, v194, v9
    v_and_b32 v18, v194, v10
    v_and_b32 v19, v194, v11
    s_nop 1
    v_mfma_f32_16x16x32_bf16 v[12:15], v[16:19], v[56:59], v[12:15]
    s_waitcnt vmcnt(5)
    v_lshl_or_b32 v195, v195, 16, v195
    v_and_b32 v20, v195, v8
    v_and_b32 v21, v195, v9
    v_and_b32 v22, v195, v10
    v_and_b32 v23, v195, v11
    s_nop 1
    v_mfma_f32_16x16x32_bf16 v[12:15], v[20:23], v[60:63], v[12:15]
    s_waitcnt vmcnt(4)
    v_lshl_or_b32 v196, v196, 16, v196
    v_and_b32 v16, v196, v8
    v_and_b32 v17, v196, v9
    v_and_b32 v18, v196, v10
    v_and_b32 v19, v196, v11
    s_nop 1
    v_mfma_f32_16x16x32_bf16 v[12:15], v[16:19], v[64:67], v[12:15]
    s_mov_b32 exec_lo, 0xffffffff
    s_mov_b32 exec_hi, 0x0
    s_nop 5
    ds_write_b128 v33, v[12:15] offset:0
    s_mov_b64 exec, -1
    s_waitcnt lgkmcnt(0)
    s_barrier
    s_and_b32 s7, s3, 3
    s_cmp_lg_u32 s7, 3
    s_cbranch_scc1 L_s1p_32
    s_setprio 2
    s_and_b32 s7, s3, 4
    s_lshl_b32 s7, s7, 9
    s_add_u32 s7, s7, 135168
    v_lshlrev_b32 v36, 3, v0
    v_add_u32 v36, s7, v36
    ds_read_b64 v[192:193], v36 offset:0
    ds_read_b64 v[194:195], v36 offset:512
    ds_read_b64 v[196:197], v36 offset:1024
    ds_read_b64 v[198:199], v36 offset:1536
    s_lshl_b32 s8, s6, 3
    s_add_u32 s8, s8, s77
    s_lshl_b32 s8, s8, 10
    s_cmp_eq_u32 s3, 3
    s_mov_b32 s9, 2359296
    s_cselect_b32 s9, 2621440, s9
    s_add_u32 s9, s9, s8
    v_mov_b32 v41, s4
    v_mov_b32 v43, s4
    s_waitcnt lgkmcnt(0)
    v_add_f32 v192, v192, v194
    v_add_f32 v193, v193, v195
    v_add_f32 v196, v196, v198
    v_add_f32 v197, v197, v199
    v_add_f32 v40, v192, v196
    v_add_f32 v42, v193, v197
    s_cmp_eq_u32 s3, 3
    s_mov_b32 s7, 3604480
    s_cselect_b32 s7, 2883584, s7
    s_add_u32 s8, s8, s7
    buffer_store_dwordx4 v[40:43], v28, s[48:51], s8 offen
    buffer_store_dwordx4 v[40:43], v28, s[48:51], s9 offen sc1
    s_setprio 0
    s_nop 0
L_s1p_32:
    s_mov_b32 s7, 32768
    buffer_load_dwordx4 v[104:107], v34, s[60:63], s7 offen nt
    s_mov_b32 s7, 40960
    buffer_load_dwordx4 v[108:111], v34, s[60:63], s7 offen nt
    s_mov_b32 s7, 49152
    buffer_load_dwordx4 v[112:115], v34, s[60:63], s7 offen nt
    s_mov_b32 s7, 57344
    buffer_load_dwordx4 v[116:119], v34, s[60:63], s7 offen nt
    s_cmp_lg_u32 s3, 3
    s_cbranch_scc1 L_qa_33
    s_setprio 2
    s_mov_b32 s15, 0
    s_cmp_lt_u32 s15, 64
    s_mov_b32 s9, 2621440
    s_cselect_b32 s9, 2883584, s9
    s_lshl_b32 s8, s6, 13
    s_add_u32 s8, s8, s9
    buffer_load_dwordx4 v[192:195], v28, s[48:51], s8 offen sc1
    s_addk_i32 s8, 0x400
    buffer_load_dwordx4 v[196:199], v28, s[48:51], s8 offen sc1
    s_addk_i32 s8, 0x400
    buffer_load_dwordx4 v[200:203], v28, s[48:51], s8 offen sc1
    s_addk_i32 s8, 0x400
    buffer_load_dwordx4 v[204:207], v28, s[48:51], s8 offen sc1
    s_addk_i32 s8, 0x400
    buffer_load_dwordx4 v[208:211], v28, s[48:51], s8 offen sc1
    s_addk_i32 s8, 0x400
    buffer_load_dwordx4 v[212:215], v28, s[48:51], s8 offen sc1
    s_addk_i32 s8, 0x400
    buffer_load_dwordx4 v[216:219], v28, s[48:51], s8 offen sc1
    s_addk_i32 s8, 0x400
    buffer_load_dwordx4 v[220:223], v28, s[48:51], s8 offen sc1
    s_waitcnt vmcnt(0)
L_qchk_34:
    v_xor_b32 v193, s4, v193
    v_xor_b32 v195, s4, v195
    v_or_b32 v36, v193, v195
    v_xor_b32 v197, s4, v197
    v_xor_b32 v199, s4, v199
    v_or3_b32 v36, v36, v197, v199
    v_xor_b32 v201, s4, v201
    v_xor_b32 v203, s4, v203
    v_or3_b32 v36, v36, v201, v203
    v_xor_b32 v205, s4, v205
    v_xor_b32 v207, s4, v207
    v_or3_b32 v36, v36, v205, v207
    v_xor_b32 v209, s4, v209
    v_xor_b32 v211, s4, v211
    v_or3_b32 v36, v36, v209, v211
    v_xor_b32 v213, s4, v213
    v_xor_b32 v215, s4, v215
    v_or3_b32 v36, v36, v213, v215
    v_xor_b32 v217, s4, v217
    v_xor_b32 v219, s4, v219
    v_or3_b32 v36, v36, v217, v219
    v_xor_b32 v221, s4, v221
    v_xor_b32 v223, s4, v223
    v_or3_b32 v36, v36, v221, v223
    v_cmp_ne_u32 vcc, 0, v36
    s_nop 0
    s_cmp_eq_u64 vcc, 0
    s_nop 2
    s_cbranch_scc1 L_qdone_35
    s_add_u32 s15, s15, 1
    s_cmp_gt_u32 s15, 200000
    s_cbranch_scc1 L_qdone_35
    s_cmp_lt_u32 s15, 64
    s_mov_b32 s9, 2621440
    s_cselect_b32 s9, 2883584, s9
    s_lshl_b32 s8, s6, 13
    s_add_u32 s8, s8, s9
    buffer_load_dwordx4 v[192:195], v28, s[48:51], s8 offen sc1
    s_addk_i32 s8, 0x400
    buffer_load_dwordx4 v[196:199], v28, s[48:51], s8 offen sc1
    s_addk_i32 s8, 0x400
    buffer_load_dwordx4 v[200:203], v28, s[48:51], s8 offen sc1
    s_addk_i32 s8, 0x400
    buffer_load_dwordx4 v[204:207], v28, s[48:51], s8 offen sc1
    s_addk_i32 s8, 0x400
    buffer_load_dwordx4 v[208:211], v28, s[48:51], s8 offen sc1
    s_addk_i32 s8, 0x400
    buffer_load_dwordx4 v[212:215], v28, s[48:51], s8 offen sc1
    s_addk_i32 s8, 0x400
    buffer_load_dwordx4 v[216:219], v28, s[48:51], s8 offen sc1
    s_addk_i32 s8, 0x400
    buffer_load_dwordx4 v[220:223], v28, s[48:51], s8 offen sc1
    s_waitcnt vmcnt(0)
    s_branch L_qchk_34
L_qdone_35:
    v_add_f32 v192, v192, v196
    v_add_f32 v194, v194, v198
    v_add_f32 v200, v200, v204
    v_add_f32 v202, v202, v206
    v_add_f32 v208, v208, v212
    v_add_f32 v210, v210, v214
    v_add_f32 v216, v216, v220
    v_add_f32 v218, v218, v222
    v_add_f32 v192, v192, v200
    v_add_f32 v194, v194, v202
    v_add_f32 v208, v208, v216
    v_add_f32 v210, v210, v218
    v_add_f32 v192, v192, v208
    v_add_f32 v194, v194, v210
    v_cvt_pk_bf16_f32 v192, v192, v194
    v_lshlrev_b32 v36, 2, v0
    v_add_u32 v36, 139264, v36
    ds_write_b32 v36, v192
    s_waitcnt lgkmcnt(0)
    s_setprio 0
L_qa_33:
    s_lshl_b32 s7, s3, 4
    s_add_u32 s8, s101, 0
    s_and_b32 s8, s8, 15
    s_add_u32 s7, s7, s8
    s_mul_i32 s8, s7, 1056
    s_lshl_b32 s7, s7, 10
    s_mov_b32 m0, s8
    s_nop 0
    buffer_load_dwordx4 v28, s[72:75], s7 offen  lds
    s_lshl_b32 s7, s3, 4
    s_add_u32 s8, s101, 1
    s_and_b32 s8, s8, 15
    s_add_u32 s7, s7, s8
    s_mul_i32 s8, s7, 1056
    s_lshl_b32 s7, s7, 10
    s_mov_b32 m0, s8
    s_nop 0
    buffer_load_dwordx4 v28, s[72:75], s7 offen  lds
    s_lshl_b32 s7, s3, 4
    s_add_u32 s8, s101, 2
    s_and_b32 s8, s8, 15
    s_add_u32 s7, s7, s8
    s_mul_i32 s8, s7, 1056
    s_lshl_b32 s7, s7, 10
    s_mov_b32 m0, s8
    s_nop 0
    buffer_load_dwordx4 v28, s[72:75], s7 offen  lds
    s_lshl_b32 s7, s3, 4
    s_add_u32 s8, s101, 3
    s_and_b32 s8, s8, 15
    s_add_u32 s7, s7, s8
    s_mul_i32 s8, s7, 1056
    s_lshl_b32 s7, s7, 10
    s_mov_b32 m0, s8
    s_nop 0
    buffer_load_dwordx4 v28, s[72:75], s7 offen  lds
    s_lshl_b32 s7, s3, 4
    s_add_u32 s8, s101, 4
    s_and_b32 s8, s8, 15
    s_add_u32 s7, s7, s8
    s_mul_i32 s8, s7, 1056
    s_lshl_b32 s7, s7, 10
    s_mov_b32 m0, s8
    s_nop 0
    buffer_load_dwordx4 v28, s[72:75], s7 offen  lds
    s_lshl_b32 s7, s3, 4
    s_add_u32 s8, s101, 5
    s_and_b32 s8, s8, 15
    s_add_u32 s7, s7, s8
    s_mul_i32 s8, s7, 1056
    s_lshl_b32 s7, s7, 10
    s_mov_b32 m0, s8
    s_nop 0
    buffer_load_dwordx4 v28, s[72:75], s7 offen  lds
    s_lshl_b32 s7, s3, 4
    s_add_u32 s8, s101, 6
    s_and_b32 s8, s8, 15
    s_add_u32 s7, s7, s8
    s_mul_i32 s8, s7, 1056
    s_lshl_b32 s7, s7, 10
    s_mov_b32 m0, s8
    s_nop 0
    buffer_load_dwordx4 v28, s[72:75], s7 offen  lds
    s_lshl_b32 s7, s3, 4
    s_add_u32 s8, s101, 7
    s_and_b32 s8, s8, 15
    s_add_u32 s7, s7, s8
    s_mul_i32 s8, s7, 1056
    s_lshl_b32 s7, s7, 10
    s_mov_b32 m0, s8
    s_nop 0
    buffer_load_dwordx4 v28, s[72:75], s7 offen  lds
    s_barrier
    v_lshlrev_b32 v36, 4, v2
    v_add_u32 v36, 139264, v36
    ds_read_b128 v[40:43], v36
    s_lshl_b32 s7, s3, 4
    s_add_u32 s8, s101, 8
    s_and_b32 s8, s8, 15
    s_add_u32 s7, s7, s8
    s_mul_i32 s8, s7, 1056
    s_lshl_b32 s7, s7, 10
    s_mov_b32 m0, s8
    s_nop 0
    buffer_load_dwordx4 v28, s[72:75], s7 offen  lds
    s_lshl_b32 s7, s3, 4
    s_add_u32 s8, s101, 9
    s_and_b32 s8, s8, 15
    s_add_u32 s7, s7, s8
    s_mul_i32 s8, s7, 1056
    s_lshl_b32 s7, s7, 10
    s_mov_b32 m0, s8
    s_nop 0
    buffer_load_dwordx4 v28, s[72:75], s7 offen  lds
    s_waitcnt lgkmcnt(0)
    s_waitcnt vmcnt(17)
    s_waitcnt vmcnt(16)
    s_waitcnt vmcnt(15)
    s_waitcnt vmcnt(14)
    v_dot2_f32_bf16 v88, v88, v40, 0
    v_dot2_f32_bf16 v92, v92, v40, 0
    v_dot2_f32_bf16 v96, v96, v40, 0
    v_dot2_f32_bf16 v100, v100, v40, 0
    v_dot2_f32_bf16 v88, v89, v41, v88
    v_dot2_f32_bf16 v92, v93, v41, v92
    v_dot2_f32_bf16 v96, v97, v41, v96
    v_dot2_f32_bf16 v100, v101, v41, v100
    v_dot2_f32_bf16 v88, v90, v42, v88
    v_dot2_f32_bf16 v92, v94, v42, v92
    v_dot2_f32_bf16 v96, v98, v42, v96
    v_dot2_f32_bf16 v100, v102, v42, v100
    v_dot2_f32_bf16 v88, v91, v43, v88
    v_dot2_f32_bf16 v92, v95, v43, v92
    v_dot2_f32_bf16 v96, v99, v43, v96
    v_dot2_f32_bf16 v100, v103, v43, v100
    s_waitcnt vmcnt(13)
    s_waitcnt vmcnt(12)
    s_waitcnt vmcnt(11)
    s_waitcnt vmcnt(10)
    v_dot2_f32_bf16 v104, v104, v40, 0
    v_dot2_f32_bf16 v108, v108, v40, 0
    v_dot2_f32_bf16 v112, v112, v40, 0
    v_dot2_f32_bf16 v116, v116, v40, 0
    v_dot2_f32_bf16 v104, v105, v41, v104
    v_dot2_f32_bf16 v108, v109, v41, v108
    v_dot2_f32_bf16 v112, v113, v41, v112
    v_dot2_f32_bf16 v116, v117, v41, v116
    v_dot2_f32_bf16 v104, v106, v42, v104
    v_dot2_f32_bf16 v108, v110, v42, v108
    v_dot2_f32_bf16 v112, v114, v42, v112
    v_dot2_f32_bf16 v116, v118, v42, v116
    v_dot2_f32_bf16 v104, v107, v43, v104
    v_dot2_f32_bf16 v108, v111, v43, v108
    v_dot2_f32_bf16 v112, v115, v43, v112
    v_dot2_f32_bf16 v116, v119, v43, v116
    v_add_f32_dpp v88, v88, v88 row_ror:8 row_mask:0xf bank_mask:0xf
    v_add_f32_dpp v92, v92, v92 row_ror:8 row_mask:0xf bank_mask:0xf
    v_add_f32_dpp v96, v96, v96 row_ror:8 row_mask:0xf bank_mask:0xf
    v_add_f32_dpp v100, v100, v100 row_ror:8 row_mask:0xf bank_mask:0xf
    v_add_f32_dpp v104, v104, v104 row_ror:8 row_mask:0xf bank_mask:0xf
    v_add_f32_dpp v108, v108, v108 row_ror:8 row_mask:0xf bank_mask:0xf
    v_add_f32_dpp v112, v112, v112 row_ror:8 row_mask:0xf bank_mask:0xf
    v_add_f32_dpp v116, v116, v116 row_ror:8 row_mask:0xf bank_mask:0xf
    v_add_f32_dpp v88, v88, v88 row_ror:4 row_mask:0xf bank_mask:0xf
    v_add_f32_dpp v92, v92, v92 row_ror:4 row_mask:0xf bank_mask:0xf
    v_add_f32_dpp v96, v96, v96 row_ror:4 row_mask:0xf bank_mask:0xf
    v_add_f32_dpp v100, v100, v100 row_ror:4 row_mask:0xf bank_mask:0xf
    v_add_f32_dpp v104, v104, v104 row_ror:4 row_mask:0xf bank_mask:0xf
    v_add_f32_dpp v108, v108, v108 row_ror:4 row_mask:0xf bank_mask:0xf
    v_add_f32_dpp v112, v112, v112 row_ror:4 row_mask:0xf bank_mask:0xf
    v_add_f32_dpp v116, v116, v116 row_ror:4 row_mask:0xf bank_mask:0xf
    v_add_f32_dpp v88, v88, v88 row_ror:2 row_mask:0xf bank_mask:0xf
    v_add_f32_dpp v92, v92, v92 row_ror:2 row_mask:0xf bank_mask:0xf
    v_add_f32_dpp v96, v96, v96 row_ror:2 row_mask:0xf bank_mask:0xf
    v_add_f32_dpp v100, v100, v100 row_ror:2 row_mask:0xf bank_mask:0xf
    v_add_f32_dpp v104, v104, v104 row_ror:2 row_mask:0xf bank_mask:0xf
    v_add_f32_dpp v108, v108, v108 row_ror:2 row_mask:0xf bank_mask:0xf
    v_add_f32_dpp v112, v112, v112 row_ror:2 row_mask:0xf bank_mask:0xf
    v_add_f32_dpp v116, v116, v116 row_ror:2 row_mask:0xf bank_mask:0xf
    v_add_f32_dpp v88, v88, v88 row_ror:1 row_mask:0xf bank_mask:0xf
    v_add_f32_dpp v92, v92, v92 row_ror:1 row_mask:0xf bank_mask:0xf
    v_add_f32_dpp v96, v96, v96 row_ror:1 row_mask:0xf bank_mask:0xf
    v_add_f32_dpp v100, v100, v100 row_ror:1 row_mask:0xf bank_mask:0xf
    v_add_f32_dpp v104, v104, v104 row_ror:1 row_mask:0xf bank_mask:0xf
    v_add_f32_dpp v108, v108, v108 row_ror:1 row_mask:0xf bank_mask:0xf
    v_add_f32_dpp v112, v112, v112 row_ror:1 row_mask:0xf bank_mask:0xf
    v_add_f32_dpp v116, v116, v116 row_ror:1 row_mask:0xf bank_mask:0xf
    v_cvt_pk_bf16_f32 v40, v88, v92
    v_cvt_pk_bf16_f32 v41, v96, v100
    v_cvt_pk_bf16_f32 v42, v104, v108
    v_cvt_pk_bf16_f32 v43, v112, v116
    v_lshlrev_b32 v36, 4, v1
    s_lshl_b32 s7, s76, 9
    s_lshl_b32 s8, s3, 6
    s_add_u32 s7, s7, s8
    s_add_u32 s7, s7, 892928
    s_mov_b32 exec_lo, 0x10001
    s_mov_b32 exec_hi, 0x10001
    buffer_store_dwordx4 v[40:43], v36, s[48:51], s7 offen sc1
    s_mov_b64 exec, -1
    s_lshl_b32 s7, s3, 4
    s_add_u32 s8, s101, 10
    s_and_b32 s8, s8, 15
    s_add_u32 s7, s7, s8
    s_mul_i32 s8, s7, 1056
    s_lshl_b32 s7, s7, 10
    s_mov_b32 m0, s8
    s_nop 0
    buffer_load_dwordx4 v28, s[72:75], s7 offen  lds
    s_lshl_b32 s7, s3, 4
    s_add_u32 s8, s101, 11
    s_and_b32 s8, s8, 15
    s_add_u32 s7, s7, s8
    s_mul_i32 s8, s7, 1056
    s_lshl_b32 s7, s7, 10
    s_mov_b32 m0, s8
    s_nop 0
    buffer_load_dwordx4 v28, s[72:75], s7 offen  lds
    s_lshl_b32 s7, s3, 4
    s_add_u32 s8, s101, 12
    s_and_b32 s8, s8, 15
    s_add_u32 s7, s7, s8
    s_mul_i32 s8, s7, 1056
    s_lshl_b32 s7, s7, 10
    s_mov_b32 m0, s8
    s_nop 0
    buffer_load_dwordx4 v28, s[72:75], s7 offen  lds
    s_lshl_b32 s7, s3, 4
    s_add_u32 s8, s101, 13
    s_and_b32 s8, s8, 15
    s_add_u32 s7, s7, s8
    s_mul_i32 s8, s7, 1056
    s_lshl_b32 s7, s7, 10
    s_mov_b32 m0, s8
    s_nop 0
    buffer_load_dwordx4 v28, s[72:75], s7 offen  lds
    s_lshl_b32 s7, s3, 4
    s_add_u32 s8, s101, 14
    s_and_b32 s8, s8, 15
    s_add_u32 s7, s7, s8
    s_mul_i32 s8, s7, 1056
    s_lshl_b32 s7, s7, 10
    s_mov_b32 m0, s8
    s_nop 0
    buffer_load_dwordx4 v28, s[72:75], s7 offen  lds
    s_lshl_b32 s7, s3, 4
    s_add_u32 s8, s101, 15
    s_and_b32 s8, s8, 15
    s_add_u32 s7, s7, s8
    s_mul_i32 s8, s7, 1056
    s_lshl_b32 s7, s7, 10
    s_mov_b32 m0, s8
    s_nop 0
    buffer_load_dwordx4 v28, s[72:75], s7 offen  lds
    s_waitcnt vmcnt(6)
    s_barrier
    s_cmp_lg_u32 s3, 0
    s_cbranch_scc1 L_fl_36
    s_lshr_b32 s7, s6, 4
    v_lshlrev_b32 v36, 1, v0
    v_add_u32 v36, s7, v36
    v_lshlrev_b32 v36, 8, v36
    s_and_b32 s7, s6, 15
    s_lshl_b32 s7, s7, 1
    s_add_u32 s7, s7, s5
    s_lshl_b32 s7, s7, 3
    s_add_u32 s7, s7, 958464
    v_mov_b32 v38, s4
    v_mov_b32 v39, s4
    s_mov_b32 exec_lo, 0xffffffff
    s_mov_b32 exec_hi, 0x0
    buffer_store_dwordx2 v[38:39], v36, s[48:51], s7 offen sc1
    s_mov_b64 exec, -1
    s_nop 0
L_fl_36:
    s_mov_b32 s7, 0
    buffer_load_dwordx4 v[120:123], v26, s[64:67], s7 offen nt
    s_mov_b32 s7, 8192
    buffer_load_dwordx4 v[124:127], v26, s[64:67], s7 offen nt
    s_mov_b32 s7, 16384
    buffer_load_dwordx4 v[128:131], v26, s[64:67], s7 offen nt
    s_mov_b32 s7, 24576
    buffer_load_dwordx4 v[132:135], v26, s[64:67], s7 offen nt
    s_lshl_b32 s7, s12, 1
    s_add_u32 s7, s7, s13
    s_lshl_b32 s7, s7, 8
    s_lshl_b32 s8, s3, 5
    s_add_u32 s7, s7, s8
    s_add_u32 s7, s7, 958464
    s_add_u32 s8, s46, s7
    s_addc_u32 s9, s47, 0
    s_mov_b32 s10, s4
    s_mov_b32 s11, s4
    s_mov_b32 s15, 0
L_fpoll_37:
    s_load_dwordx8 s[92:99], s[8:9], 0 glc
    s_waitcnt lgkmcnt(0)
    s_xor_b64 s[92:93], s[92:93], s[10:11]
    s_xor_b64 s[94:95], s[94:95], s[10:11]
    s_xor_b64 s[96:97], s[96:97], s[10:11]
    s_xor_b64 s[98:99], s[98:99], s[10:11]
    s_or_b64 s[92:93], s[92:93], s[94:95]
    s_or_b64 s[96:97], s[96:97], s[98:99]
    s_or_b64 s[92:93], s[92:93], s[96:97]
    s_cmp_eq_u64 s[92:93], 0
    s_cbranch_scc1 L_fdone_38
    s_add_u32 s15, s15, 1
    s_cmp_gt_u32 s15, 200000
    s_cbranch_scc1 L_fdone_38
    s_branch L_fpoll_37
L_fdone_38:
    s_lshl_b32 s7, s13, 14
    s_lshl_b32 s8, s3, 11
    s_add_u32 s7, s7, s8
    s_add_u32 s7, s7, 892928
    buffer_load_dwordx4 v[192:195], v28, s[48:51], s7 offen offset:0 sc1
    buffer_load_dwordx4 v[196:199], v28, s[48:51], s7 offen offset:1024 sc1
    s_mov_b32 s7, 32768
    buffer_load_dwordx4 v[136:139], v26, s[64:67], s7 offen nt
    s_mov_b32 s7, 40960
    buffer_load_dwordx4 v[140:143], v26, s[64:67], s7 offen nt
    s_waitcnt vmcnt(2)
    s_mul_i32 s7, s3, 2112
    s_add_u32 s7, s7, 135168
    v_add_u32 v36, s7, v28
    ds_write_b128 v36, v[192:195]
    ds_write_b128 v36, v[196:199] offset:1056
    s_waitcnt lgkmcnt(0)
    s_barrier
    s_mov_b32 s7, 49152
    buffer_load_dwordx4 v[144:147], v26, s[64:67], s7 offen nt
    s_mov_b32 s7, 57344
    buffer_load_dwordx4 v[148:151], v26, s[64:67], s7 offen nt
    s_mov_b32 s7, 0
    buffer_load_dwordx4 v[152:155], v27, s[68:71], s7 offen offset:0 nt
    s_mov_b32 s7, 0
    buffer_load_dwordx4 v[156:159], v27, s[68:71], s7 offen offset:256 nt
    s_mov_b32 s7, 0
    buffer_load_dwordx4 v[160:163], v27, s[68:71], s7 offen offset:512 nt
    s_lshl_b32 s7, s3, 4
    v_add_u32 v36, s7, v2
    v_mul_u32_u24 v36, 1056, v36
    v_lshlrev_b32 v38, 4, v1
    v_add_u32 v36, v36, v38
    v_mul_u32_u24 v37, 1056, v2
    v_add_u32 v37, v37, v38
    v_add_u32 v37, 135168, v37
    ds_read_b128 v[192:195], v36 offset:0
    ds_read_b128 v[196:199], v37 offset:0
    ds_read_b128 v[200:203], v36 offset:64
    ds_read_b128 v[204:207], v37 offset:64
    ds_read_b128 v[208:211], v36 offset:128
    ds_read_b128 v[212:215], v37 offset:128
    ds_read_b128 v[216:219], v36 offset:192
    ds_read_b128 v[220:223], v37 offset:192
    ds_read_b128 v[224:227], v36 offset:256
    ds_read_b128 v[228:231], v37 offset:256
    ds_read_b128 v[232:235], v36 offset:320
    ds_read_b128 v[236:239], v37 offset:320
    ds_read_b128 v[240:243], v36 offset:384
    ds_read_b128 v[244:247], v37 offset:384
    ds_read_b128 v[248:251], v36 offset:448
    ds_read_b128 v[252:255], v37 offset:448
    s_waitcnt lgkmcnt(14)
    v_mfma_f32_16x16x32_bf16 v[12:15], v[192:195], v[196:199], 0
    s_waitcnt lgkmcnt(12)
    v_mfma_f32_16x16x32_bf16 v[12:15], v[200:203], v[204:207], v[12:15]
    s_waitcnt lgkmcnt(10)
    v_mfma_f32_16x16x32_bf16 v[12:15], v[208:211], v[212:215], v[12:15]
    s_waitcnt lgkmcnt(8)
    v_mfma_f32_16x16x32_bf16 v[12:15], v[216:219], v[220:223], v[12:15]
    ds_read_b128 v[192:195], v36 offset:512
    ds_read_b128 v[196:199], v37 offset:512
    ds_read_b128 v[200:203], v36 offset:576
    ds_read_b128 v[204:207], v37 offset:576
    ds_read_b128 v[208:211], v36 offset:640
    ds_read_b128 v[212:215], v37 offset:640
    ds_read_b128 v[216:219], v36 offset:704
    ds_read_b128 v[220:223], v37 offset:704
    s_waitcnt lgkmcnt(14)
    v_mfma_f32_16x16x32_bf16 v[12:15], v[224:227], v[228:231], v[12:15]
    s_waitcnt lgkmcnt(12)
    v_mfma_f32_16x16x32_bf16 v[12:15], v[232:235], v[236:239], v[12:15]
    s_waitcnt lgkmcnt(10)
    v_mfma_f32_16x16x32_bf16 v[12:15], v[240:243], v[244:247], v[12:15]
    s_waitcnt lgkmcnt(8)
    v_mfma_f32_16x16x32_bf16 v[12:15], v[248:251], v[252:255], v[12:15]
    ds_read_b128 v[224:227], v36 offset:768
    ds_read_b128 v[228:231], v37 offset:768
    ds_read_b128 v[232:235], v36 offset:832
    ds_read_b128 v[236:239], v37 offset:832
    ds_read_b128 v[240:243], v36 offset:896
    ds_read_b128 v[244:247], v37 offset:896
    ds_read_b128 v[248:251], v36 offset:960
    ds_read_b128 v[252:255], v37 offset:960
    s_waitcnt lgkmcnt(14)
    v_mfma_f32_16x16x32_bf16 v[12:15], v[192:195], v[196:199], v[12:15]
    s_waitcnt lgkmcnt(12)
    v_mfma_f32_16x16x32_bf16 v[12:15], v[200:203], v[204:207], v[12:15]
    s_waitcnt lgkmcnt(10)
    v_mfma_f32_16x16x32_bf16 v[12:15], v[208:211], v[212:215], v[12:15]
    s_waitcnt lgkmcnt(8)
    v_mfma_f32_16x16x32_bf16 v[12:15], v[216:219], v[220:223], v[12:15]
    s_waitcnt lgkmcnt(6)
    v_mfma_f32_16x16x32_bf16 v[12:15], v[224:227], v[228:231], v[12:15]
    s_waitcnt lgkmcnt(4)
    v_mfma_f32_16x16x32_bf16 v[12:15], v[232:235], v[236:239], v[12:15]
    s_waitcnt lgkmcnt(2)
    v_mfma_f32_16x16x32_bf16 v[12:15], v[240:243], v[244:247], v[12:15]
    s_waitcnt lgkmcnt(0)
    v_mfma_f32_16x16x32_bf16 v[12:15], v[248:251], v[252:255], v[12:15]
    s_mov_b32 s7, 0x3e0293ee
    s_nop 6
    v_mul_f32 v40, s7, v12
    v_mul_f32 v41, s7, v13
    v_mul_f32 v42, s7, v14
    v_mul_f32 v43, s7, v15
    v_max3_f32 v38, v40, v41, v42
    v_max_f32 v38, v38, v43
    v_mov_b32 v39, v38
    s_nop 1
    v_permlane16_swap_b32 v38, v39
    v_max_f32 v38, v38, v39
    v_mov_b32 v39, v38
    s_nop 1
    v_permlane32_swap_b32 v38, v39
    v_max_f32 v38, v38, v39
    v_lshlrev_b32 v24, 5, v2
    v_add_u32 v24, 156928, v24
    s_lshl_b32 s7, s3, 2
    v_add_u32 v39, s7, v24
    s_mov_b32 exec_lo, 0xffff
    s_mov_b32 exec_hi, 0x0
    ds_write_b32 v39, v38
    s_mov_b64 exec, -1
    s_waitcnt lgkmcnt(0)
    s_barrier
    ds_read_b128 v[192:195], v24
    ds_read_b128 v[196:199], v24 offset:16
    s_waitcnt lgkmcnt(0)
    v_max3_f32 v25, v192, v193, v194
    v_max3_f32 v25, v25, v195, v196
    v_max3_f32 v25, v25, v197, v198
    v_max_f32 v25, v25, v199
    v_sub_f32 v40, v40, v25
    v_sub_f32 v41, v41, v25
    v_sub_f32 v42, v42, v25
    v_sub_f32 v43, v43, v25
    v_exp_f32 v40, v40
    v_exp_f32 v41, v41
    v_exp_f32 v42, v42
    v_exp_f32 v43, v43
    v_cvt_pk_bf16_f32 v44, v40, v41
    v_cvt_pk_bf16_f32 v45, v42, v43
    s_mov_b32 s7, 0xffff0000
    v_lshlrev_b32 v40, 16, v44
    v_and_b32 v41, s7, v44
    v_lshlrev_b32 v42, 16, v45
    v_and_b32 v43, s7, v45
    v_add_f32 v40, v40, v41
    v_add_f32 v42, v42, v43
    v_add_f32 v40, v40, v42
    v_mov_b32 v41, v40
    s_nop 1
    v_permlane16_swap_b32 v40, v41
    v_add_f32 v40, v40, v41
    v_mov_b32 v41, v40
    s_nop 1
    v_permlane32_swap_b32 v40, v41
    v_add_f32 v40, v40, v41
    v_mul_u32_u24 v36, 288, v2
    v_lshlrev_b32 v37, 4, v1
    v_add_u32 v36, v36, v37
    v_add_u32 v36, 152064, v36
    v_mov_b32 v30, v36
    s_lshr_b32 s7, s3, 1
    s_lshl_b32 s7, s7, 6
    s_and_b32 s8, s3, 1
    s_lshl_b32 s8, s8, 3
    s_add_u32 s7, s7, s8
    v_add_u32 v36, s7, v36
    ds_write_b64 v36, v[44:45]
    v_add_u32 v39, 512, v39
    s_mov_b32 exec_lo, 0xffff
    s_mov_b32 exec_hi, 0x0
    ds_write_b32 v39, v40
    s_mov_b64 exec, -1
    s_waitcnt lgkmcnt(0)
    s_barrier
    s_mov_b32 s7, 0
    buffer_load_dwordx4 v[164:167], v27, s[68:71], s7 offen offset:768 nt
    s_mov_b32 s7, 0
    buffer_load_dwordx4 v[168:171], v27, s[68:71], s7 offen offset:1024 nt
    s_mov_b32 s7, 5120
    buffer_load_dwordx4 v[172:175], v27, s[68:71], s7 offen offset:0 nt
    ds_read_b128 v[48:51], v30 offset:0
    ds_read_b128 v[52:55], v30 offset:64
    ds_read_b128 v[56:59], v30 offset:128
    ds_read_b128 v[60:63], v30 offset:192
    v_lshrrev_b32 v38, 2, v2
    v_lshl_add_u32 v38, v1, 2, v38
    v_mul_u32_u24 v36, 1056, v38
    v_and_b32 v38, 3, v2
    v_lshlrev_b32 v38, 3, v38
    s_lshl_b32 s7, s3, 7
    v_add3_u32 v36, v36, v38, s7
    v_add_u32 v37, 67584, v36
    ds_read_b64_tr_b16 v[88:89], v36 offset:0
    ds_read_b64_tr_b16 v[90:91], v36 offset:16896
    ds_read_b64_tr_b16 v[92:93], v36 offset:33792
    ds_read_b64_tr_b16 v[94:95], v36 offset:50688
    ds_read_b64_tr_b16 v[96:97], v37 offset:0
    ds_read_b64_tr_b16 v[98:99], v37 offset:16896
    ds_read_b64_tr_b16 v[100:101], v37 offset:33792
    ds_read_b64_tr_b16 v[102:103], v37 offset:50688
    ds_read_b64_tr_b16 v[192:193], v36 offset:32
    ds_read_b64_tr_b16 v[194:195], v36 offset:16928
    ds_read_b64_tr_b16 v[196:197], v36 offset:33824
    ds_read_b64_tr_b16 v[198:199], v36 offset:50720
    ds_read_b64_tr_b16 v[200:201], v37 offset:32
    ds_read_b64_tr_b16 v[202:203], v37 offset:16928
    ds_read_b64_tr_b16 v[204:205], v37 offset:33824
    ds_read_b64_tr_b16 v[206:207], v37 offset:50720
    s_waitcnt lgkmcnt(14)
    v_mfma_f32_16x16x32_bf16 v[64:67], v[88:91], v[48:51], 0
    s_waitcnt lgkmcnt(12)
    v_mfma_f32_16x16x32_bf16 v[64:67], v[92:95], v[52:55], v[64:67]
    s_waitcnt lgkmcnt(10)
    v_mfma_f32_16x16x32_bf16 v[64:67], v[96:99], v[56:59], v[64:67]
    s_waitcnt lgkmcnt(8)
    v_mfma_f32_16x16x32_bf16 v[64:67], v[100:103], v[60:63], v[64:67]
    ds_read_b64_tr_b16 v[88:89], v36 offset:64
    ds_read_b64_tr_b16 v[90:91], v36 offset:16960
    ds_read_b64_tr_b16 v[92:93], v36 offset:33856
    ds_read_b64_tr_b16 v[94:95], v36 offset:50752
    ds_read_b64_tr_b16 v[96:97], v37 offset:64
    ds_read_b64_tr_b16 v[98:99], v37 offset:16960
    ds_read_b64_tr_b16 v[100:101], v37 offset:33856
    ds_read_b64_tr_b16 v[102:103], v37 offset:50752
    s_waitcnt lgkmcnt(14)
    v_mfma_f32_16x16x32_bf16 v[68:71], v[192:195], v[48:51], 0
    s_waitcnt lgkmcnt(12)
    v_mfma_f32_16x16x32_bf16 v[68:71], v[196:199], v[52:55], v[68:71]
    s_waitcnt lgkmcnt(10)
    v_mfma_f32_16x16x32_bf16 v[68:71], v[200:203], v[56:59], v[68:71]
    s_waitcnt lgkmcnt(8)
    v_mfma_f32_16x16x32_bf16 v[68:71], v[204:207], v[60:63], v[68:71]
    ds_read_b64_tr_b16 v[192:193], v36 offset:96
    ds_read_b64_tr_b16 v[194:195], v36 offset:16992
    ds_read_b64_tr_b16 v[196:197], v36 offset:33888
    ds_read_b64_tr_b16 v[198:199], v36 offset:50784
    ds_read_b64_tr_b16 v[200:201], v37 offset:96
    ds_read_b64_tr_b16 v[202:203], v37 offset:16992
    ds_read_b64_tr_b16 v[204:205], v37 offset:33888
    ds_read_b64_tr_b16 v[206:207], v37 offset:50784
    s_waitcnt lgkmcnt(14)
    v_mfma_f32_16x16x32_bf16 v[72:75], v[88:91], v[48:51], 0
    s_waitcnt lgkmcnt(12)
    v_mfma_f32_16x16x32_bf16 v[72:75], v[92:95], v[52:55], v[72:75]
    s_waitcnt lgkmcnt(10)
    v_mfma_f32_16x16x32_bf16 v[72:75], v[96:99], v[56:59], v[72:75]
    s_waitcnt lgkmcnt(8)
    v_mfma_f32_16x16x32_bf16 v[72:75], v[100:103], v[60:63], v[72:75]
    s_waitcnt lgkmcnt(6)
    v_mfma_f32_16x16x32_bf16 v[76:79], v[192:195], v[48:51], 0
    s_waitcnt lgkmcnt(4)
    v_mfma_f32_16x16x32_bf16 v[76:79], v[196:199], v[52:55], v[76:79]
    s_waitcnt lgkmcnt(2)
    v_mfma_f32_16x16x32_bf16 v[76:79], v[200:203], v[56:59], v[76:79]
    s_waitcnt lgkmcnt(0)
    v_mfma_f32_16x16x32_bf16 v[76:79], v[204:207], v[60:63], v[76:79]
    v_mul_u32_u24 v36, 1056, v2
    v_lshlrev_b32 v37, 3, v1
    s_lshl_b32 s7, s3, 7
    s_add_u32 s7, s7, 135168
    v_add3_u32 v36, v36, v37, s7
    v_cvt_pk_bf16_f32 v64, v64, v65
    v_cvt_pk_bf16_f32 v65, v66, v67
    ds_write_b64 v36, v[64:65] offset:0
    v_cvt_pk_bf16_f32 v68, v68, v69
    v_cvt_pk_bf16_f32 v69, v70, v71
    ds_write_b64 v36, v[68:69] offset:32
    v_cvt_pk_bf16_f32 v72, v72, v73
    v_cvt_pk_bf16_f32 v73, v74, v75
    ds_write_b64 v36, v[72:73] offset:64
    v_cvt_pk_bf16_f32 v76, v76, v77
    v_cvt_pk_bf16_f32 v77, v78, v79
    ds_write_b64 v36, v[76:77] offset:96
    s_waitcnt lgkmcnt(0)
    s_barrier
    s_mul_i32 s7, s3, 2112
    s_add_u32 s7, s7, 135168
    v_add_u32 v36, s7, v28
    ds_read_b128 v[224:227], v36
    ds_read_b128 v[228:231], v36 offset:1056
    v_add_u32 v37, 512, v24
    ds_read_b128 v[232:235], v37
    ds_read_b128 v[236:239], v37 offset:16
    s_lshl_b32 s7, s13, 4
    s_lshl_b32 s8, s3, 1
    s_add_u32 s7, s7, s8
    s_lshl_b32 s7, s7, 5
    s_add_u32 s7, s7, s12
    s_lshl_b32 s7, s7, 10
    s_add_u32 s7, s7, 1048576
    s_add_u32 s8, s7, 32768
    s_mov_b32 s14, s7
    s_waitcnt lgkmcnt(0)
    s_cmp_lg_u32 s3, 0
    s_cbranch_scc1 L_ml_39
    v_add_f32 v232, v232, v233
    v_add_f32 v234, v234, v235
    v_add_f32 v236, v236, v237
    v_add_f32 v238, v238, v239
    v_add_f32 v232, v232, v234
    v_add_f32 v236, v236, v238
    v_add_f32 v39, v232, v236
    v_mov_b32 v38, v25
    v_lshlrev_b32 v37, 8, v2
    s_lshl_b32 s7, s13, 12
    s_lshl_b32 s9, s12, 3
    s_add_u32 s7, s7, s9
    s_add_u32 s7, s7, 974848
    s_mov_b32 exec_lo, 0xffff
    s_mov_b32 exec_hi, 0x0
    buffer_store_dwordx2 v[38:39], v37, s[48:51], s7 offen sc1
    s_mov_b64 exec, -1
    s_nop 0
L_ml_39:
    buffer_store_dwordx4 v[224:227], v28, s[48:51], s14 offen sc1
    buffer_store_dwordx4 v[228:231], v28, s[48:51], s8 offen sc1
    s_waitcnt vmcnt(0)
    s_barrier
    s_cmp_lg_u32 s3, 0
    s_cbranch_scc1 L_fl2_40
    v_lshlrev_b32 v36, 8, v0
    s_lshl_b32 s7, s13, 13
    s_lshl_b32 s8, s12, 3
    s_add_u32 s7, s7, s8
    s_add_u32 s7, s7, 983040
    v_mov_b32 v38, s4
    v_mov_b32 v39, s4
    s_mov_b32 exec_lo, 0xffffffff
    s_mov_b32 exec_hi, 0x0
    buffer_store_dwordx2 v[38:39], v36, s[48:51], s7 offen sc1
    s_mov_b64 exec, -1
    s_nop 0
L_fl2_40:
    s_mov_b32 s7, 5120
    buffer_load_dwordx4 v[176:179], v27, s[68:71], s7 offen offset:256 nt
    s_mov_b32 s7, 5120
    buffer_load_dwordx4 v[180:183], v27, s[68:71], s7 offen offset:512 nt
    s_mov_b32 s7, 5120
    buffer_load_dwordx4 v[184:187], v27, s[68:71], s7 offen offset:768 nt
    s_mov_b32 s7, 5120
    buffer_load_dwordx4 v[188:191], v27, s[68:71], s7 offen offset:1024 nt
    s_lshl_b32 s7, s76, 8
    s_lshl_b32 s8, s3, 5
    s_add_u32 s7, s7, s8
    s_add_u32 s7, s7, 983040
    s_add_u32 s8, s46, s7
    s_addc_u32 s9, s47, 0
    s_mov_b32 s10, s4
    s_mov_b32 s11, s4
    s_mov_b32 s15, 0
L_fpoll_41:
    s_load_dwordx8 s[92:99], s[8:9], 0 glc
    s_waitcnt lgkmcnt(0)
    s_xor_b64 s[92:93], s[92:93], s[10:11]
    s_xor_b64 s[94:95], s[94:95], s[10:11]
    s_xor_b64 s[96:97], s[96:97], s[10:11]
    s_xor_b64 s[98:99], s[98:99], s[10:11]
    s_or_b64 s[92:93], s[92:93], s[94:95]
    s_or_b64 s[96:97], s[96:97], s[98:99]
    s_or_b64 s[92:93], s[92:93], s[96:97]
    s_cmp_eq_u64 s[92:93], 0
    s_cbranch_scc1 L_fdone_42
    s_add_u32 s15, s15, 1
    s_cmp_gt_u32 s15, 200000
    s_cbranch_scc1 L_fdone_42
    s_branch L_fpoll_41
L_fdone_42:
    s_barrier
    v_and_b32 v30, 7, v0
    v_and_b32 v36, 31, v0
    v_lshlrev_b32 v36, 3, v36
    s_lshl_b32 s7, s6, 8
    s_add_u32 s7, s7, 974848
    buffer_load_dwordx2 v[38:39], v36, s[48:51], s7 offen sc1
    v_lshlrev_b32 v36, 10, v29
    v_lshlrev_b32 v37, 4, v30
    s_lshl_b32 s7, s3, 7
    v_add3_u32 v36, v36, v37, s7
    s_lshl_b32 s7, s6, 15
    s_add_u32 s7, s7, 1048576
    buffer_load_dwordx4 v[48:51], v36, s[48:51], s7 offen sc1
    s_addk_i32 s7, 0x2000
    buffer_load_dwordx4 v[52:55], v36, s[48:51], s7 offen sc1
    s_addk_i32 s7, 0x2000
    buffer_load_dwordx4 v[56:59], v36, s[48:51], s7 offen sc1
    s_addk_i32 s7, 0x2000
    buffer_load_dwordx4 v[60:63], v36, s[48:51], s7 offen sc1
    s_waitcnt vmcnt(4)
    v_mov_b32 v40, v38
    s_nop 1
    v_max_f32_dpp v40, v40, v40 row_ror:8 row_mask:0xf bank_mask:0xf
    s_nop 1
    v_max_f32_dpp v40, v40, v40 row_ror:4 row_mask:0xf bank_mask:0xf
    s_nop 1
    v_max_f32_dpp v40, v40, v40 row_ror:2 row_mask:0xf bank_mask:0xf
    s_nop 1
    v_max_f32_dpp v40, v40, v40 row_ror:1 row_mask:0xf bank_mask:0xf
    v_mov_b32 v41, v40
    s_nop 1
    v_permlane16_swap_b32 v40, v41
    v_max_f32 v40, v40, v41
    v_sub_f32 v40, v38, v40
    v_exp_f32 v40, v40
    s_nop 0
    v_mul_f32 v41, v40, v39
    s_nop 1
    v_add_f32_dpp v41, v41, v41 row_ror:8 row_mask:0xf bank_mask:0xf
    s_nop 1
    v_add_f32_dpp v41, v41, v41 row_ror:4 row_mask:0xf bank_mask:0xf
    s_nop 1
    v_add_f32_dpp v41, v41, v41 row_ror:2 row_mask:0xf bank_mask:0xf
    s_nop 1
    v_add_f32_dpp v41, v41, v41 row_ror:1 row_mask:0xf bank_mask:0xf
    v_mov_b32 v42, v41
    s_nop 1
    v_permlane16_swap_b32 v41, v42
    v_add_f32 v41, v41, v42
    v_rcp_f32 v41, v41
    s_nop 0
    v_mul_f32 v40, v40, v41
    v_cvt_pk_bf16_f32 v40, v40, v40
    v_lshlrev_b32 v41, 2, v29
    ds_bpermute_b32 v64, v41, v40
    v_add_u32 v41, 32, v41
    ds_bpermute_b32 v65, v41, v40
    v_add_u32 v41, 32, v41
    ds_bpermute_b32 v66, v41, v40
    v_add_u32 v41, 32, v41
    ds_bpermute_b32 v67, v41, v40
    s_waitcnt lgkmcnt(0)
    s_waitcnt vmcnt(0)
    s_waitcnt vmcnt(3)
    v_and_b32 v16, v64, v4
    v_and_b32 v17, v64, v5
    v_and_b32 v18, v64, v6
    v_and_b32 v19, v64, v7
    s_nop 1
    v_mfma_f32_16x16x32_bf16 v[12:15], v[16:19], v[48:51], 0
    s_waitcnt vmcnt(2)
    v_and_b32 v20, v65, v4
    v_and_b32 v21, v65, v5
    v_and_b32 v22, v65, v6
    v_and_b32 v23, v65, v7
    s_nop 1
    v_mfma_f32_16x16x32_bf16 v[12:15], v[20:23], v[52:55], v[12:15]
    s_waitcnt vmcnt(1)
    v_and_b32 v16, v66, v4
    v_and_b32 v17, v66, v5
    v_and_b32 v18, v66, v6
    v_and_b32 v19, v66, v7
    s_nop 1
    v_mfma_f32_16x16x32_bf16 v[12:15], v[16:19], v[56:59], v[12:15]
    s_waitcnt vmcnt(0)
    v_and_b32 v20, v67, v4
    v_and_b32 v21, v67, v5
    v_and_b32 v22, v67, v6
    v_and_b32 v23, v67, v7
    s_nop 1
    v_mfma_f32_16x16x32_bf16 v[12:15], v[20:23], v[60:63], v[12:15]
    v_lshlrev_b32 v36, 5, v30
    v_lshlrev_b32 v37, 4, v1
    v_and_b32 v38, 1, v1
    v_lshlrev_b32 v38, 4, v38
    v_lshrrev_b32 v39, 1, v1
    v_lshlrev_b32 v39, 8, v39
    v_add3_u32 v36, v36, v38, v39
    s_lshl_b32 s7, s3, 9
    v_add_u32 v36, s7, v36
    s_mov_b32 exec_lo, 0xff00ff
    s_mov_b32 exec_hi, 0xff00ff00
    ds_write_b128 v36, v[12:15]
    s_mov_b64 exec, -1
    v_lshlrev_b32 v37, 5, v29
    v_add_u32 v37, s7, v37
    s_waitcnt lgkmcnt(0)
    ds_read_b128 v[68:71], v37
    ds_read_b128 v[72:75], v37 offset:16
    ds_read_b128 v[76:79], v37 offset:256
    ds_read_b128 v[80:83], v37 offset:272
    s_waitcnt lgkmcnt(0)
    v_add_f32 v68, v68, v76
    v_add_f32 v69, v69, v77
    v_add_f32 v70, v70, v78
    v_add_f32 v71, v71, v79
    v_add_f32 v72, v72, v80
    v_add_f32 v73, v73, v81
    v_add_f32 v74, v74, v82
    v_add_f32 v75, v75, v83
    v_cvt_pk_bf16_f32 v68, v68, v68
    v_cvt_pk_bf16_f32 v69, v69, v69
    v_cvt_pk_bf16_f32 v70, v70, v70
    v_cvt_pk_bf16_f32 v71, v71, v71
    v_cvt_pk_bf16_f32 v72, v72, v72
    v_cvt_pk_bf16_f32 v73, v73, v73
    v_cvt_pk_bf16_f32 v74, v74, v74
    v_cvt_pk_bf16_f32 v75, v75, v75
    v_and_b32 v16, v68, v4
    v_and_b32 v17, v68, v5
    v_and_b32 v18, v68, v6
    v_and_b32 v19, v68, v7
    s_nop 1
    v_mfma_f32_16x16x32_bf16 v[12:15], v[16:19], v[120:123], 0
    v_and_b32 v20, v69, v4
    v_and_b32 v21, v69, v5
    v_and_b32 v22, v69, v6
    v_and_b32 v23, v69, v7
    s_nop 1
    v_mfma_f32_16x16x32_bf16 v[12:15], v[20:23], v[124:127], v[12:15]
    v_and_b32 v16, v70, v4
    v_and_b32 v17, v70, v5
    v_and_b32 v18, v70, v6
    v_and_b32 v19, v70, v7
    s_nop 1
    v_mfma_f32_16x16x32_bf16 v[12:15], v[16:19], v[128:131], v[12:15]
    v_and_b32 v20, v71, v4
    v_and_b32 v21, v71, v5
    v_and_b32 v22, v71, v6
    v_and_b32 v23, v71, v7
    s_nop 1
    v_mfma_f32_16x16x32_bf16 v[12:15], v[20:23], v[132:135], v[12:15]
    v_and_b32 v16, v72, v4
    v_and_b32 v17, v72, v5
    v_and_b32 v18, v72, v6
    v_and_b32 v19, v72, v7
    s_nop 1
    v_mfma_f32_16x16x32_bf16 v[12:15], v[16:19], v[136:139], v[12:15]
    v_and_b32 v20, v73, v4
    v_and_b32 v21, v73, v5
    v_and_b32 v22, v73, v6
    v_and_b32 v23, v73, v7
    s_nop 1
    v_mfma_f32_16x16x32_bf16 v[12:15], v[20:23], v[140:143], v[12:15]
    v_and_b32 v16, v74, v4
    v_and_b32 v17, v74, v5
    v_and_b32 v18, v74, v6
    v_and_b32 v19, v74, v7
    s_nop 1
    v_mfma_f32_16x16x32_bf16 v[12:15], v[16:19], v[144:147], v[12:15]
    v_and_b32 v20, v75, v4
    v_and_b32 v21, v75, v5
    v_and_b32 v22, v75, v6
    v_and_b32 v23, v75, v7
    s_nop 1
    v_mfma_f32_16x16x32_bf16 v[12:15], v[20:23], v[148:151], v[12:15]
    v_lshlrev_b32 v36, 5, v30
    v_and_b32 v38, 1, v1
    v_lshlrev_b32 v38, 4, v38
    v_lshrrev_b32 v39, 1, v1
    v_lshlrev_b32 v39, 8, v39
    v_add3_u32 v36, v36, v38, v39
    s_mul_i32 s7, s3, 528
    s_add_u32 s7, s7, 4096
    v_add_u32 v36, s7, v36
    s_mov_b32 exec_lo, 0xff00ff
    s_mov_b32 exec_hi, 0xff00ff00
    ds_write_b128 v36, v[12:15]
    s_mov_b64 exec, -1
    v_mul_u32_u24 v36, 528, v30
    v_lshrrev_b32 v38, 3, v2
    v_lshl_add_u32 v38, v38, 2, v1
    s_lshl_b32 s7, s3, 3
    v_add_u32 v38, s7, v38
    v_lshl_add_u32 v36, v38, 2, v36
    s_waitcnt lgkmcnt(0)
    s_barrier
    ds_read_b32 v38, v36 offset:4096
    ds_read_b32 v39, v36 offset:4352
    s_waitcnt lgkmcnt(0)
    v_add_f32 v38, v38, v39
    s_nop 1
    v_add_f32_dpp v38, v38, v38 row_half_mirror row_mask:0xf bank_mask:0xf
    s_nop 1
    v_add_f32_dpp v38, v38, v38 quad_perm:[2,3,0,1] row_mask:0xf bank_mask:0xf
    s_nop 1
    v_add_f32_dpp v38, v38, v38 quad_perm:[1,0,3,2] row_mask:0xf bank_mask:0xf
    v_cvt_pk_bf16_f32 v38, v38, v38
    s_nop 1
    v_and_b32_dpp v16, v38, v8 row_newbcast:0 row_mask:0xf bank_mask:0xf
    v_and_b32_dpp v17, v38, v9 row_newbcast:0 row_mask:0xf bank_mask:0xf
    v_and_b32_dpp v18, v38, v10 row_newbcast:0 row_mask:0xf bank_mask:0xf
    v_and_b32_dpp v19, v38, v11 row_newbcast:0 row_mask:0xf bank_mask:0xf
    v_and_b32_dpp v20, v38, v8 row_newbcast:8 row_mask:0xf bank_mask:0xf
    v_and_b32_dpp v21, v38, v9 row_newbcast:8 row_mask:0xf bank_mask:0xf
    v_and_b32_dpp v22, v38, v10 row_newbcast:8 row_mask:0xf bank_mask:0xf
    v_and_b32_dpp v23, v38, v11 row_newbcast:8 row_mask:0xf bank_mask:0xf
    v_mfma_f32_16x16x32_bf16 v[64:67], v[16:19], v[152:155], 0
    v_mfma_f32_16x16x32_bf16 v[68:71], v[16:19], v[156:159], 0
    v_mfma_f32_16x16x32_bf16 v[72:75], v[16:19], v[160:163], 0
    v_mfma_f32_16x16x32_bf16 v[76:79], v[16:19], v[164:167], 0
    v_mfma_f32_16x16x32_bf16 v[80:83], v[16:19], v[168:171], 0
    v_mfma_f32_16x16x32_bf16 v[64:67], v[20:23], v[172:175], v[64:67]
    v_mfma_f32_16x16x32_bf16 v[68:71], v[20:23], v[176:179], v[68:71]
    v_mfma_f32_16x16x32_bf16 v[72:75], v[20:23], v[180:183], v[72:75]
    v_mfma_f32_16x16x32_bf16 v[76:79], v[20:23], v[184:187], v[76:79]
    v_mfma_f32_16x16x32_bf16 v[80:83], v[20:23], v[188:191], v[80:83]
    v_lshlrev_b32 v36, 5, v2
    v_lshlrev_b32 v37, 4, v1
    s_mul_i32 s7, s3, 2560
    s_add_u32 s7, s7, 12288
    v_add3_u32 v36, v36, v37, s7
    s_mov_b32 exec_lo, 0xffffffff
    s_mov_b32 exec_hi, 0x0
    ds_write_b128 v36, v[64:67] offset:0
    ds_write_b128 v36, v[68:71] offset:512
    ds_write_b128 v36, v[72:75] offset:1024
    ds_write_b128 v36, v[76:79] offset:1536
    ds_write_b128 v36, v[80:83] offset:2048
    s_mov_b64 exec, -1
    s_waitcnt lgkmcnt(0)
    s_barrier
    s_cmp_ge_u32 s3, 5
    s_cbranch_scc1 L_nopub_43
    s_lshl_b32 s7, s3, 9
    v_lshlrev_b32 v36, 3, v0
    v_add_u32 v36, s7, v36
    ds_read_b64 v[48:49], v36 offset:12288
    ds_read_b64 v[50:51], v36 offset:14848
    ds_read_b64 v[52:53], v36 offset:17408
    ds_read_b64 v[54:55], v36 offset:19968
    ds_read_b64 v[56:57], v36 offset:22528
    ds_read_b64 v[58:59], v36 offset:25088
    ds_read_b64 v[60:61], v36 offset:27648
    ds_read_b64 v[62:63], v36 offset:30208
    v_mov_b32 v41, s4
    v_mov_b32 v43, s4
    s_mul_i32 s7, s100, 5120
    s_lshl_b32 s8, s3, 10
    s_add_u32 s7, s7, s8
    s_add_u32 s7, s7, 565248
    s_waitcnt lgkmcnt(0)
    v_add_f32 v48, v48, v50
    v_add_f32 v49, v49, v51
    v_add_f32 v52, v52, v54
    v_add_f32 v53, v53, v55
    v_add_f32 v56, v56, v58
    v_add_f32 v57, v57, v59
    v_add_f32 v60, v60, v62
    v_add_f32 v61, v61, v63
    v_add_f32 v48, v48, v52
    v_add_f32 v49, v49, v53
    v_add_f32 v56, v56, v60
    v_add_f32 v57, v57, v61
    v_add_f32 v40, v48, v56
    v_add_f32 v42, v49, v57
    buffer_store_dwordx4 v[40:43], v28, s[48:51], s7 offen sc1
    s_nop 1
L_nopub_43:
    s_cmp_ge_u32 s100, 40
    s_cbranch_scc1 L_aend_44
    s_cmp_lg_u32 s3, 5
    s_cbranch_scc1 L_aend_44
    s_mov_b32 s52, s42
    s_mov_b32 s53, s43
    s_mov_b32 s54, 2560
    s_mov_b32 s55, 0x20000
    s_lshl_b32 s7, s100, 7
    s_add_u32 s10, s7, 565248
    s_lshl_b32 s14, s100, 5
    v_lshrrev_b32 v36, 3, v0
    v_mul_u32_u24 v36, 5120, v36
    v_and_b32 v37, 7, v0
    v_lshlrev_b32 v37, 4, v37
    v_add_u32 v36, v36, v37
    s_mov_b32 s15, 0
    s_mov_b32 s7, s10
    buffer_load_dwordx4 v[48:51], v36, s[48:51], s7 offen sc1
    s_add_u32 s7, s7, 40960
    buffer_load_dwordx4 v[52:55], v36, s[48:51], s7 offen sc1
    s_add_u32 s7, s7, 40960
    buffer_load_dwordx4 v[56:59], v36, s[48:51], s7 offen sc1
    s_add_u32 s7, s7, 40960
    buffer_load_dwordx4 v[60:63], v36, s[48:51], s7 offen sc1
    s_add_u32 s7, s7, 40960
    buffer_load_dwordx4 v[64:67], v36, s[48:51], s7 offen sc1
    s_add_u32 s7, s7, 40960
    buffer_load_dwordx4 v[68:71], v36, s[48:51], s7 offen sc1
    s_add_u32 s7, s7, 40960
    buffer_load_dwordx4 v[72:75], v36, s[48:51], s7 offen sc1
    s_add_u32 s7, s7, 40960
    buffer_load_dwordx4 v[76:79], v36, s[48:51], s7 offen sc1
L_pl_45:
    s_mov_b32 s7, s10
    buffer_load_dwordx4 v[80:83], v36, s[48:51], s7 offen sc1
    s_add_u32 s7, s7, 40960
    buffer_load_dwordx4 v[84:87], v36, s[48:51], s7 offen sc1
    s_add_u32 s7, s7, 40960
    buffer_load_dwordx4 v[88:91], v36, s[48:51], s7 offen sc1
    s_add_u32 s7, s7, 40960
    buffer_load_dwordx4 v[92:95], v36, s[48:51], s7 offen sc1
    s_add_u32 s7, s7, 40960
    buffer_load_dwordx4 v[96:99], v36, s[48:51], s7 offen sc1
    s_add_u32 s7, s7, 40960
    buffer_load_dwordx4 v[100:103], v36, s[48:51], s7 offen sc1
    s_add_u32 s7, s7, 40960
    buffer_load_dwordx4 v[104:107], v36, s[48:51], s7 offen sc1
    s_add_u32 s7, s7, 40960
    buffer_load_dwordx4 v[108:111], v36, s[48:51], s7 offen sc1
    s_waitcnt vmcnt(8)
    v_xor_b32 v49, s4, v49
    v_xor_b32 v51, s4, v51
    v_or_b32 v38, v49, v51
    v_xor_b32 v53, s4, v53
    v_xor_b32 v55, s4, v55
    v_or3_b32 v38, v38, v53, v55
    v_xor_b32 v57, s4, v57
    v_xor_b32 v59, s4, v59
    v_or3_b32 v38, v38, v57, v59
    v_xor_b32 v61, s4, v61
    v_xor_b32 v63, s4, v63
    v_or3_b32 v38, v38, v61, v63
    v_xor_b32 v65, s4, v65
    v_xor_b32 v67, s4, v67
    v_or3_b32 v38, v38, v65, v67
    v_xor_b32 v69, s4, v69
    v_xor_b32 v71, s4, v71
    v_or3_b32 v38, v38, v69, v71
    v_xor_b32 v73, s4, v73
    v_xor_b32 v75, s4, v75
    v_or3_b32 v38, v38, v73, v75
    v_xor_b32 v77, s4, v77
    v_xor_b32 v79, s4, v79
    v_or3_b32 v38, v38, v77, v79
    v_cmp_ne_u32 vcc, 0, v38
    s_nop 0
    s_cmp_eq_u64 vcc, 0
    s_cbranch_scc1 L_ok0_46
    s_mov_b32 s7, s10
    buffer_load_dwordx4 v[48:51], v36, s[48:51], s7 offen sc1
    s_add_u32 s7, s7, 40960
    buffer_load_dwordx4 v[52:55], v36, s[48:51], s7 offen sc1
    s_add_u32 s7, s7, 40960
    buffer_load_dwordx4 v[56:59], v36, s[48:51], s7 offen sc1
    s_add_u32 s7, s7, 40960
    buffer_load_dwordx4 v[60:63], v36, s[48:51], s7 offen sc1
    s_add_u32 s7, s7, 40960
    buffer_load_dwordx4 v[64:67], v36, s[48:51], s7 offen sc1
    s_add_u32 s7, s7, 40960
    buffer_load_dwordx4 v[68:71], v36, s[48:51], s7 offen sc1
    s_add_u32 s7, s7, 40960
    buffer_load_dwordx4 v[72:75], v36, s[48:51], s7 offen sc1
    s_add_u32 s7, s7, 40960
    buffer_load_dwordx4 v[76:79], v36, s[48:51], s7 offen sc1
    s_waitcnt vmcnt(8)
    v_xor_b32 v81, s4, v81
    v_xor_b32 v83, s4, v83
    v_or_b32 v38, v81, v83
    v_xor_b32 v85, s4, v85
    v_xor_b32 v87, s4, v87
    v_or3_b32 v38, v38, v85, v87
    v_xor_b32 v89, s4, v89
    v_xor_b32 v91, s4, v91
    v_or3_b32 v38, v38, v89, v91
    v_xor_b32 v93, s4, v93
    v_xor_b32 v95, s4, v95
    v_or3_b32 v38, v38, v93, v95
    v_xor_b32 v97, s4, v97
    v_xor_b32 v99, s4, v99
    v_or3_b32 v38, v38, v97, v99
    v_xor_b32 v101, s4, v101
    v_xor_b32 v103, s4, v103
    v_or3_b32 v38, v38, v101, v103
    v_xor_b32 v105, s4, v105
    v_xor_b32 v107, s4, v107
    v_or3_b32 v38, v38, v105, v107
    v_xor_b32 v109, s4, v109
    v_xor_b32 v111, s4, v111
    v_or3_b32 v38, v38, v109, v111
    v_cmp_ne_u32 vcc, 0, v38
    s_nop 0
    s_cmp_eq_u64 vcc, 0
    s_cbranch_scc1 L_ok1_47
    s_add_u32 s15, s15, 1
    s_cmp_le_u32 s15, 200000
    s_cbranch_scc1 L_pl_45
L_ok1_47:
    v_add_f32 v80, v80, v96
    v_add_f32 v82, v82, v98
    v_add_f32 v84, v84, v100
    v_add_f32 v86, v86, v102
    v_add_f32 v88, v88, v104
    v_add_f32 v90, v90, v106
    v_add_f32 v92, v92, v108
    v_add_f32 v94, v94, v110
    v_add_f32 v80, v80, v88
    v_add_f32 v82, v82, v90
    v_add_f32 v84, v84, v92
    v_add_f32 v86, v86, v94
    v_add_f32 v112, v80, v84
    v_add_f32 v114, v82, v86
    s_branch L_pout_48
    s_nop 0
L_ok0_46:
    v_add_f32 v48, v48, v64
    v_add_f32 v50, v50, v66
    v_add_f32 v52, v52, v68
    v_add_f32 v54, v54, v70
    v_add_f32 v56, v56, v72
    v_add_f32 v58, v58, v74
    v_add_f32 v60, v60, v76
    v_add_f32 v62, v62, v78
    v_add_f32 v48, v48, v56
    v_add_f32 v50, v50, v58
    v_add_f32 v52, v52, v60
    v_add_f32 v54, v54, v62
    v_add_f32 v112, v48, v52
    v_add_f32 v114, v50, v54
    s_nop 1
L_pout_48:
    v_add_f32_dpp v112, v112, v112 row_ror:8 row_mask:0xf bank_mask:0xf
    v_add_f32_dpp v114, v114, v114 row_ror:8 row_mask:0xf bank_mask:0xf
    v_mov_b32 v38, v112
    v_mov_b32 v39, v114
    s_nop 0
    v_permlane16_swap_b32 v112, v38
    v_permlane16_swap_b32 v114, v39
    v_add_f32 v112, v112, v38
    v_add_f32 v114, v114, v39
    v_mov_b32 v38, v112
    v_mov_b32 v39, v114
    s_nop 0
    v_permlane32_swap_b32 v112, v38
    v_permlane32_swap_b32 v114, v39
    v_add_f32 v112, v112, v38
    v_add_f32 v114, v114, v39
    v_cvt_pk_bf16_f32 v112, v112, v114
    v_lshlrev_b32 v36, 2, v0
    s_mov_b32 exec_lo, 0xff
    s_mov_b32 exec_hi, 0x0
    buffer_store_dword v112, v36, s[52:55], s14 offen
    s_mov_b64 exec, -1
    s_cmp_lg_u32 s100, 0
    s_cbranch_scc1 L_aend_44
    v_mov_b32 v36, 0
    v_mov_b32 v37, s4
    s_mov_b32 exec_lo, 0x1
    s_mov_b32 exec_hi, 0x0
    buffer_store_dword v37, v36, s[48:51], 0 offen sc1
    s_mov_b64 exec, -1
    s_nop 0
L_aend_44:
    s_endpgm
L_end:
    s_endpgm
.section .rodata,"a"
.p2align 6
.amdhsa_kernel concat_heads__compressed_kv_cla__mha_block_cached__decode_kernel
  .amdhsa_next_free_vgpr 256
  .amdhsa_next_free_sgpr 102
  .amdhsa_accum_offset 256
  .amdhsa_group_segment_fixed_size 0
  .amdhsa_kernarg_size 112
  .amdhsa_user_sgpr_count 2
  .amdhsa_user_sgpr_kernarg_segment_ptr 1
  .amdhsa_system_sgpr_workgroup_id_x 1
.end_amdhsa_kernel
```
